```python
import torch

def _softmax(x, axis=-1):
    return torch.softmax(x, dim=axis)
def _gelu(x):
    return torch.nn.functional.gelu(x, approximate="tanh")
def _silu(x):
    return torch.nn.functional.silu(x)
def _sigmoid(x):
    return torch.sigmoid(x)
def _layernorm(x, axis=-1, eps=1e-5):
    m = x.mean(dim=axis, keepdim=True)
    v = x.var(dim=axis, keepdim=True, unbiased=False)
    return (x - m) / torch.sqrt(v + eps)
def _scatter_add(tgt, idx, src, axis=0):
    return tgt.clone().index_add_(axis, idx, src)
def _segment_sum(src, seg, n):
    out = torch.zeros((n,) + src.shape[1:], dtype=src.dtype)
    return out.index_add_(0, seg, src)
def _pad(x, pw):
    flat = tuple(v for pair in reversed(pw) for v in pair)
    return torch.nn.functional.pad(x, flat)

kernel_name = 'interleave_layers__spectral_fnet__moe_arch_mod__prompt'

def setup_inputs():

    _w = (lambda a: (lambda t: t.to(torch.bfloat16) if t.is_floating_point() else t)(torch.as_tensor(a)))
    def _A_setup():
        B, S, D = 1, 2048, 512
        ns = torch.arange(S)[:, None] * torch.arange(S)[None, :]
        nd = torch.arange(D)[:, None] * torch.arange(D)[None, :]
        Ws_re = torch.cos(-2.0 * torch.pi * ns / S).to(float)
        Ws_im = torch.sin(-2.0 * torch.pi * ns / S).to(float)
        Wd_re = torch.cos(-2.0 * torch.pi * nd / D).to(float)
        Wd_im = torch.sin(-2.0 * torch.pi * nd / D).to(float)
        return {
            "x": _w((lambda *s: torch.randn(*s, dtype=torch.bfloat16) * 0.05)(B, S, D)),
            "dft_seq_re": _w(Ws_re),
            "dft_seq_im": _w(Ws_im),
            "dft_hid_re": _w(Wd_re),
            "dft_hid_im": _w(Wd_im),
        }
    _A_in = _A_setup()

    def _B_setup():
        B, S, D, F, C = 1, 2048, 512, 1792, 2
        return {
            "x": _w((lambda *s: torch.randn(*s, dtype=torch.bfloat16) * 0.05)(B, S, D)),
            "w_r": _w((lambda *s: torch.randn(*s, dtype=torch.bfloat16) * 1.6)(D)),
            "w_gate": _w((lambda *s: torch.randn(*s, dtype=torch.bfloat16) * 0.4)(D, F)),
            "w_up": _w((lambda *s: torch.randn(*s, dtype=torch.bfloat16) * 0.4)(D, F)),
            "w_down": _w((lambda *s: torch.randn(*s, dtype=torch.bfloat16) * 0.4)(F, D)),
        }
    _B_in = _B_setup()

    return {
        "A_x": _A_in["x"],
        "A_dft_seq_re": _A_in["dft_seq_re"],
        "A_dft_seq_im": _A_in["dft_seq_im"],
        "A_dft_hid_re": _A_in["dft_hid_re"],
        "A_dft_hid_im": _A_in["dft_hid_im"],
        "B_x": _B_in["x"],
        "B_w_r": _B_in["w_r"],
        "B_w_gate": _B_in["w_gate"],
        "B_w_up": _B_in["w_up"],
        "B_w_down": _B_in["w_down"],
    }

def reference(A_x, A_dft_seq_re, A_dft_seq_im, A_dft_hid_re, A_dft_hid_im, B_x, B_w_r, B_w_gate, B_w_up, B_w_down):
    def _A_ref(x, dft_seq_re, dft_seq_im, dft_hid_re, dft_hid_im):
        a = torch.einsum("bsd,ed->bse", x, dft_hid_re)
        b = torch.einsum("bsd,ed->bse", x, dft_hid_im)
        y = torch.einsum("ts,bse->bte", dft_seq_re, a) - torch.einsum("ts,bse->bte", dft_seq_im, b)
        return y

    def _B_ref(x, w_r, w_gate, w_up, w_down):
        B, S, D = x.shape
        C = 2
        r = x @ w_r
        idx = torch.argsort(-r, axis=-1)[:, :C]
        idx_e = (lambda x, n, axis: torch.repeat_interleave(x, n, dim=axis))(idx.reshape(B, C, 1), D, axis=2)
        x_sel = (lambda x, i, axis: torch.take_along_dim(x, i, dim=axis))(x, idx_e, axis=1)
        g = _silu(x_sel @ w_gate)
        u = x_sel @ w_up
        y = (g * u) @ w_down
        r_sel = _sigmoid((lambda x, i, axis: torch.take_along_dim(x, i, dim=axis))(r, idx, axis=1))
        y = y * r_sel.reshape(B, C, 1)
        b_off = (torch.arange(B) * S).reshape(B, 1)
        flat_idx = (idx + b_off).reshape(B * C)
        zero = (x * 0.0).reshape(B * S, D)
        upd = _scatter_add(zero, flat_idx, y.reshape(B * C, D), axis=0)
        return x + upd.reshape(B, S, D)

    x = A_x
    x = x + _A_ref(_layernorm(x, axis=-1), A_dft_seq_re, A_dft_seq_im, A_dft_hid_re, A_dft_hid_im)
    x = x + _B_ref(_layernorm(x, axis=-1), B_w_r, B_w_gate, B_w_up, B_w_down)
    x = x + _A_ref(_layernorm(x, axis=-1), A_dft_seq_re, A_dft_seq_im, A_dft_hid_re, A_dft_hid_im)
    x = x + _B_ref(_layernorm(x, axis=-1), B_w_r, B_w_gate, B_w_up, B_w_down)
    return x
```

```asm
; @launch grid=(505,1,1) block=(256,1,1) lds=59648
.amdgcn_target "amdgcn-amd-amdhsa--gfx950"
.text
.globl interleave_layers__spectral_fnet__moe_arch_mod__prompt_kernel
.p2align 8
.type interleave_layers__spectral_fnet__moe_arch_mod__prompt_kernel,@function
interleave_layers__spectral_fnet__moe_arch_mod__prompt_kernel:
  s_load_dwordx2 s[32:33], s[0:1], 0
  s_load_dwordx2 s[30:31], s[0:1], 96
  s_load_dwordx8 s[44:51], s[0:1], 48
  s_load_dwordx2 s[58:59], s[0:1], 80
  s_memrealtime s[96:97]
  s_getpc_b64 s[62:63]
  v_lshlrev_b32 v2, 7, v0
  v_min_u32 v2, CODE_END, v2
  global_load_dword v239, v2, s[62:63]
  v_lshrrev_b32 v1, 6, v0
  s_sub_u32 s3, s2, 257
  v_readfirstlane_b32 s22, v1
  s_cbranch_scc0 L_ffn
  s_lshr_b32 s20, s2, 3
  s_and_b32 s21, s2, 7
  s_cmp_eq_u32 s20, 0
  s_cselect_b32 s26, s21, 0
  s_cmp_ge_u32 s26, 4
  s_cselect_b32 s20, 32, s20
  s_cselect_b32 s26, 4, 0
  s_sub_u32 s21, s21, s26
  s_cmp_eq_u32 s2, 256
  s_cselect_b32 s20, 0, s20
  s_cselect_b32 s21, 4, s21
  s_cselect_b32 s60, s22, 0
  s_lshl_b32 s23, s21, 2
  s_add_u32 s23, s23, s22
  s_lshl_b32 s23, s23, 6
  s_add_u32 s23, s23, s20
  s_sub_u32 s24, 2048, s23
  s_and_b32 s24, s24, 2047
  s_lshl_b32 s28, s23, 10
  s_lshl_b32 s29, s24, 10
  v_and_b32 v2, 15, v0
  v_bfe_u32 v3, v0, 4, 2
  v_lshl_add_u32 v4, v2, 2, v3
  v_lshlrev_b32 v5, 4, v4
  v_sub_u32 v6, 1008, v5
  v_sub_u32 v7, 1024, v5
  v_and_b32 v7, 1023, v7
  s_lshr_b32 s36, s2, 1
  s_mul_i32 s36, s36, 8320
  s_bitcmp1_b32 s2, 0
  s_cselect_b32 s37, 4096, 0
  s_add_u32 s36, s36, s37
  s_cmp_eq_u32 s2, 256
  s_cselect_b32 s36, 8192, s36
  s_cselect_b32 s37, 8192, 0
  s_add_u32 s36, s36, 0x320000
  v_lshlrev_b32 v11, 4, v0
  v_lshrrev_b32 v9, 3, v0
  v_mad_u32_u24 v9, v9, s37, v11
  v_mov_b32 v188, -1
  v_mov_b32 v189, -1
  v_mov_b32 v190, -1
  v_mov_b32 v191, -1
  s_mov_b32 s6, 0x10000000
  s_mov_b32 s7, 0x20000
  s_mov_b32 s10, 0x200000
  s_mov_b32 s11, 0x20000
  s_waitcnt lgkmcnt(0)
  s_mov_b32 s8, s32
  s_mov_b32 s9, s33
  buffer_load_dwordx4 v[172:175], v5, s[8:11], s28 offen
  buffer_load_dwordx4 v[176:179], v6, s[8:11], s29 offen
  buffer_load_ushort v192, v7, s[8:11], s29 offen
  s_mov_b32 s4, s30
  s_mov_b32 s5, s31
  buffer_store_dwordx4 v[188:191], v9, s[4:7], s36 offen sc0 sc1
  s_add_u32 s38, s30, 0x7c1000
  s_addc_u32 s39, s31, 0
  s_load_dword s40, s[38:39], 0
  s_mov_b32 s12, s44
  s_mov_b32 s13, s45
  s_mov_b32 s14, 0x400
  s_mov_b32 s15, 0x20000
  s_mov_b32 s16, s58
  s_mov_b32 s17, s59
  s_mov_b32 s18, 0x200000
  s_mov_b32 s19, 0x20000
  buffer_load_dwordx4 v[180:183], v5, s[12:15], 0 offen
  buffer_load_dwordx4 v[184:187], v6, s[12:15], 0 offen
  buffer_load_ushort v193, v7, s[12:15], 0 offen
  v_and_b32 v1, 63, v0
  s_cmp_lg_u32 s2, 256
  s_cbranch_scc1 M_clr2
  s_add_u32 s36, s36, 266240
  buffer_store_dwordx4 v[188:191], v9, s[4:7], s36 offen sc0 sc1
  s_add_u32 s36, s36, 266240
  buffer_store_dwordx4 v[188:191], v9, s[4:7], s36 offen sc0 sc1
  s_add_u32 s36, s36, 266240
  buffer_store_dwordx4 v[188:191], v9, s[4:7], s36 offen sc0 sc1
  M_clr2:
  s_lshl_b32 s25, s21, 10
  s_lshl_b32 s26, s20, 4
  s_add_u32 s25, s25, s26
  s_sub_u32 s27, 8192, s25
  s_lshl_b32 s26, s21, 4
  s_add_u32 s36, s26, 8192
  s_sub_u32 s37, 8308, s26
  s_cmp_eq_u32 s20, 0
  s_cselect_b32 s25, s36, s25
  s_cselect_b32 s27, s37, s27
  s_cmp_ge_u32 s22, 2
  s_cselect_b32 s25, s27, s25
  v_and_b32 v8, 127, v0
  v_mul_u32_u24 v8, 8320, v8
  s_lshl_b32 s61, s2, 12
  s_add_u32 s61, s61, 0x210000
  s_bfe_u32 s37, s2, 0x40004
  s_and_b32 s36, s2, 7
  s_lshl_b32 s36, s36, 4
  s_add_u32 s3, s37, s36
  s_mul_i32 s41, s3, 8320
  s_bfe_u32 s26, s2, 0x10003
  s_lshl_b32 s26, s26, 5
  s_lshr_b32 s37, s22, 1
  s_lshl_b32 s37, s37, 4
  s_add_u32 s26, s26, s37
  s_and_b32 s27, s22, 1
  v_add_u32 v9, s26, v2
  v_lshl_add_u32 v10, s27, 2, v3
  v_lshlrev_b32 v20, 10, v10
  v_lshl_add_u32 v20, v9, 4, v20
  v_cmp_eq_u32 vcc, 0, v9
  v_lshlrev_b32 v10, 4, v10
  v_add_u32 v10, 8192, v10
  v_cndmask_b32 v20, v20, v10, vcc
  s_cmp_lg_u32 s2, 256
  s_cbranch_scc1 M_clr3
  buffer_store_dwordx4 v[188:191], v11, s[4:7], s61 offen sc0 sc1
  M_clr3:
  v_cmp_lt_u32 s[44:45], 31, v4
  v_add_u32 v9, 1, v4
  s_nop 0
  v_cndmask_b32 v9, v4, v9, s[44:45]
  v_and_b32 v9, 63, v9
  v_cmp_eq_u32 vcc, 0, v9
  s_nop 1
  v_cndmask_b32 v9, v9, 32, vcc
  v_and_b32 v10, 3, v9
  v_and_b32 v12, 60, v9
  v_lshl_add_u32 v12, v10, 6, v12
  v_sub_u32 v9, 95, v4
  v_cndmask_b32 v9, v4, v9, s[44:45]
  s_lshl_b32 s36, s22, 2
  s_sub_u32 s37, 4108, s36
  s_add_u32 s36, s36, 4096
  v_mov_b32 v10, s36
  v_mov_b32 v13, s37
  v_cndmask_b32 v13, v10, v13, s[44:45]
  v_lshl_add_u32 v13, v9, 6, v13
  v_add_u32 v9, 1, v4
  v_and_b32 v9, 63, v9
  v_and_b32 v10, 3, v9
  v_and_b32 v14, 60, v9
  v_lshl_add_u32 v14, v10, 6, v14
  v_and_b32 v9, 2, v0
  v_lshlrev_b32 v9, 10, v9
  v_and_b32 v10, 1, v0
  v_lshl_add_u32 v9, v10, 3, v9
  v_and_b32 v10, 252, v0
  v_lshl_add_u32 v30, v10, 2, v9
  v_mov_b32 v9, 0
  v_lshlrev_b32 v10, 2, v2
  ds_write_b32 v10, v9 offset:8192
  v_lshrrev_b32 v9, 5, v0
  v_mul_u32_u24 v9, 144, v9
  v_bfe_u32 v10, v0, 2, 3
  v_lshl_add_u32 v9, v10, 4, v9
  v_and_b32 v10, 2, v0
  v_cmp_ne_u32 s[38:39], 0, v10
  v_sub_u32 v10, 9328, v9
  v_mov_b32 v198, 1152
  v_mov_b32 v199, -1152
  v_cndmask_b32 v23, v9, v10, s[38:39]
  v_cndmask_b32 v198, v198, v199, s[38:39]
  v_lshrrev_b32 v199, 6, v9
  v_add_u32 v10, 4544, v9
  v_cmp_eq_u32 vcc, 1, v199
  s_nop 1
  v_cndmask_b32 v9, v9, v10, vcc
  v_sub_u32 v10, 9328, v9
  v_sub_u32 v22, 116, v9
  v_cmp_eq_u32 vcc, 0, v199
  s_nop 1
  v_cndmask_b32 v10, v10, v22, vcc
  v_cndmask_b32 v22, v9, v10, s[38:39]
  v_and_b32 v9, 1, v0
  v_lshl_add_u32 v22, v9, 3, v22
  v_lshl_add_u32 v23, v9, 3, v23
  v_add_u32 v22, 12544, v22
  v_add_u32 v23, v23, v198
  v_add_u32 v24, v23, v198
  v_add_u32 v25, v24, v198
  v_lshrrev_b32 v9, 4, v0
  v_mul_u32_u24 v9, 144, v9
  v_bfe_u32 v10, v0, 1, 3
  v_lshl_add_u32 v9, v10, 4, v9
  v_and_b32 v10, 1, v0
  v_cmp_ne_u32 s[38:39], 0, v10
  v_sub_u32 v10, 9328, v9
  v_mov_b32 v198, 2304
  v_mov_b32 v199, -2304
  v_cndmask_b32 v27, v9, v10, s[38:39]
  v_cndmask_b32 v198, v198, v199, s[38:39]
  v_lshrrev_b32 v199, 6, v9
  v_add_u32 v10, 4544, v9
  v_cmp_eq_u32 vcc, 1, v199
  s_nop 1
  v_cndmask_b32 v9, v9, v10, vcc
  v_sub_u32 v10, 9328, v9
  v_sub_u32 v26, 116, v9
  v_cmp_eq_u32 vcc, 0, v199
  s_nop 1
  v_cndmask_b32 v10, v10, v26, vcc
  v_cndmask_b32 v26, v9, v10, s[38:39]
  v_add_u32 v26, 12544, v26
  v_add_u32 v27, v27, v198
  v_lshrrev_b32 v9, 2, v0
  v_and_b32 v10, 3, v0
  v_lshlrev_b32 v9, 13, v9
  v_lshl_add_u32 v28, v10, 4, v9
  v_lshrrev_b32 v9, 1, v0
  v_and_b32 v10, 1, v0
  v_lshlrev_b32 v31, 4, v9
  v_lshl_add_u32 v31, v10, 11, v31
  v_lshlrev_b32 v9, 12, v9
  v_lshl_add_u32 v29, v10, 4, v9
  v_mul_u32_u24 v19, 144, v2
  v_lshl_add_u32 v19, v3, 5, v19
  v_add_u32 v9, s26, v2
  v_cvt_f32_u32 v196, v9
  v_cvt_f32_u32 v197, v3
  v_mul_f32 v201, 0x3c800000, v196
  v_add_f32 v202, v201, v201
  v_mul_f32 v10, 0x41800000, v197
  v_mul_f32 v10, v10, v201
  v_mov_b32 v200, v10
  v_cos_f32 v198, v200
  v_sin_f32 v199, v200
  s_nop 0
  v_cvt_pk_f16_f32 v108, v198, v199
  v_cvt_pk_f16_f32 v112, -v199, v198
  v_add_f32 v200, v200, v202
  v_cos_f32 v198, v200
  v_sin_f32 v199, v200
  s_nop 0
  v_cvt_pk_f16_f32 v109, v198, v199
  v_cvt_pk_f16_f32 v113, -v199, v198
  v_add_f32 v200, v200, v202
  v_cos_f32 v198, v200
  v_sin_f32 v199, v200
  s_nop 0
  v_cvt_pk_f16_f32 v110, v198, v199
  v_cvt_pk_f16_f32 v114, -v199, v198
  v_add_f32 v200, v200, v202
  v_cos_f32 v198, v200
  v_sin_f32 v199, v200
  s_nop 0
  v_cvt_pk_f16_f32 v111, v198, v199
  v_cvt_pk_f16_f32 v115, -v199, v198
  v_add_f32 v200, v200, v202
  v_cos_f32 v198, v200
  v_sin_f32 v199, v200
  s_nop 0
  v_cvt_pk_f16_f32 v116, v198, v199
  v_cvt_pk_f16_f32 v120, -v199, v198
  v_add_f32 v200, v200, v202
  v_cos_f32 v198, v200
  v_sin_f32 v199, v200
  s_nop 0
  v_cvt_pk_f16_f32 v117, v198, v199
  v_cvt_pk_f16_f32 v121, -v199, v198
  v_add_f32 v200, v200, v202
  v_cos_f32 v198, v200
  v_sin_f32 v199, v200
  s_nop 0
  v_cvt_pk_f16_f32 v118, v198, v199
  v_cvt_pk_f16_f32 v122, -v199, v198
  v_add_f32 v200, v200, v202
  v_cos_f32 v198, v200
  v_sin_f32 v199, v200
  s_nop 0
  v_cvt_pk_f16_f32 v119, v198, v199
  v_cvt_pk_f16_f32 v123, -v199, v198
  v_add_f32 v200, v10, v201
  v_cos_f32 v198, v200
  v_sin_f32 v199, v200
  s_nop 0
  v_cvt_pk_f16_f32 v124, v198, v199
  v_cvt_pk_f16_f32 v128, -v199, v198
  v_add_f32 v200, v200, v202
  v_cos_f32 v198, v200
  v_sin_f32 v199, v200
  s_nop 0
  v_cvt_pk_f16_f32 v125, v198, v199
  v_cvt_pk_f16_f32 v129, -v199, v198
  v_add_f32 v200, v200, v202
  v_cos_f32 v198, v200
  v_sin_f32 v199, v200
  s_nop 0
  v_cvt_pk_f16_f32 v126, v198, v199
  v_cvt_pk_f16_f32 v130, -v199, v198
  v_add_f32 v200, v200, v202
  v_cos_f32 v198, v200
  v_sin_f32 v199, v200
  s_nop 0
  v_cvt_pk_f16_f32 v127, v198, v199
  v_cvt_pk_f16_f32 v131, -v199, v198
  v_add_f32 v200, v200, v202
  v_cos_f32 v198, v200
  v_sin_f32 v199, v200
  s_nop 0
  v_cvt_pk_f16_f32 v132, v198, v199
  v_cvt_pk_f16_f32 v136, -v199, v198
  v_add_f32 v200, v200, v202
  v_cos_f32 v198, v200
  v_sin_f32 v199, v200
  s_nop 0
  v_cvt_pk_f16_f32 v133, v198, v199
  v_cvt_pk_f16_f32 v137, -v199, v198
  v_add_f32 v200, v200, v202
  v_cos_f32 v198, v200
  v_sin_f32 v199, v200
  s_nop 0
  v_cvt_pk_f16_f32 v134, v198, v199
  v_cvt_pk_f16_f32 v138, -v199, v198
  v_add_f32 v200, v200, v202
  v_cos_f32 v198, v200
  v_sin_f32 v199, v200
  s_nop 0
  v_cvt_pk_f16_f32 v135, v198, v199
  v_cvt_pk_f16_f32 v139, -v199, v198
  v_mul_f32 v201, 0x3a000000, v196
  v_mul_f32 v197, 4.0, v197
  s_mov_b32 s38, 0x3e000000
  s_mov_b32 s39, 0x41500000
  v_mul_f32 v200, v197, v201
  v_cos_f32 v198, v200
  v_sin_f32 v199, v200
  v_mul_f32 v140, s38, v198
  v_mul_f32 v141, s38, v199
  v_add_f32 v200, v200, v201
  v_cos_f32 v198, v200
  v_sin_f32 v199, v200
  v_mul_f32 v142, s38, v198
  v_mul_f32 v143, s38, v199
  v_add_f32 v200, v200, v201
  v_cos_f32 v198, v200
  v_sin_f32 v199, v200
  v_mul_f32 v144, s38, v198
  v_mul_f32 v145, s38, v199
  v_add_f32 v200, v200, v201
  v_cos_f32 v198, v200
  v_sin_f32 v199, v200
  v_mul_f32 v146, s38, v198
  v_mul_f32 v147, s38, v199
  v_fmac_f32 v200, s39, v201
  v_cos_f32 v198, v200
  v_sin_f32 v199, v200
  v_mul_f32 v148, s38, v198
  v_mul_f32 v149, s38, v199
  v_add_f32 v200, v200, v201
  v_cos_f32 v198, v200
  v_sin_f32 v199, v200
  v_mul_f32 v150, s38, v198
  v_mul_f32 v151, s38, v199
  v_add_f32 v200, v200, v201
  v_cos_f32 v198, v200
  v_sin_f32 v199, v200
  v_mul_f32 v152, s38, v198
  v_mul_f32 v153, s38, v199
  v_add_f32 v200, v200, v201
  v_cos_f32 v198, v200
  v_sin_f32 v199, v200
  v_mul_f32 v154, s38, v198
  v_mul_f32 v155, s38, v199
  v_lshl_add_u32 v9, s27, 4, v2
  v_cvt_f32_u32 v196, v9
  v_mul_f32 v201, 0x3d000000, v196
  v_mul_f32 v200, v197, v201
  v_cos_f32 v198, v200
  v_sin_f32 v199, v200
  s_nop 0
  v_cvt_pk_f16_f32 v156, v198, v199
  v_cvt_pk_f16_f32 v164, -v199, v198
  v_add_f32 v200, v200, v201
  v_cos_f32 v198, v200
  v_sin_f32 v199, v200
  s_nop 0
  v_cvt_pk_f16_f32 v157, v198, v199
  v_cvt_pk_f16_f32 v165, -v199, v198
  v_add_f32 v200, v200, v201
  v_cos_f32 v198, v200
  v_sin_f32 v199, v200
  s_nop 0
  v_cvt_pk_f16_f32 v158, v198, v199
  v_cvt_pk_f16_f32 v166, -v199, v198
  v_add_f32 v200, v200, v201
  v_cos_f32 v198, v200
  v_sin_f32 v199, v200
  s_nop 0
  v_cvt_pk_f16_f32 v159, v198, v199
  v_cvt_pk_f16_f32 v167, -v199, v198
  v_fmac_f32 v200, s39, v201
  v_cos_f32 v198, v200
  v_sin_f32 v199, v200
  s_nop 0
  v_cvt_pk_f16_f32 v160, v198, v199
  v_cvt_pk_f16_f32 v168, -v199, v198
  v_add_f32 v200, v200, v201
  v_cos_f32 v198, v200
  v_sin_f32 v199, v200
  s_nop 0
  v_cvt_pk_f16_f32 v161, v198, v199
  v_cvt_pk_f16_f32 v169, -v199, v198
  v_add_f32 v200, v200, v201
  v_cos_f32 v198, v200
  v_sin_f32 v199, v200
  s_nop 0
  v_cvt_pk_f16_f32 v162, v198, v199
  v_cvt_pk_f16_f32 v170, -v199, v198
  v_add_f32 v200, v200, v201
  v_cos_f32 v198, v200
  v_sin_f32 v199, v200
  s_nop 0
  v_cvt_pk_f16_f32 v163, v198, v199
  v_cvt_pk_f16_f32 v171, -v199, v198
  s_cmp_lg_u32 s60, 0
  s_cbranch_scc1 M_pr
  s_setprio 2
  M_pr:
  s_waitcnt vmcnt(4) lgkmcnt(0)
  s_mul_i32 s40, s40, 0x9e3779b1
  s_add_u32 s40, s40, 0x7f4a7c15
  v_lshlrev_b32 v38, 16, v172
  v_and_b32 v39, 0xffff0000, v172
  v_lshlrev_b32 v40, 16, v173
  v_and_b32 v41, 0xffff0000, v173
  v_lshlrev_b32 v42, 16, v174
  v_and_b32 v43, 0xffff0000, v174
  v_lshlrev_b32 v44, 16, v175
  v_and_b32 v45, 0xffff0000, v175
  v_lshlrev_b32 v46, 16, v192
  v_and_b32 v47, 0xffff0000, v179
  v_lshlrev_b32 v48, 16, v179
  v_and_b32 v49, 0xffff0000, v178
  v_lshlrev_b32 v50, 16, v178
  v_and_b32 v51, 0xffff0000, v177
  v_lshlrev_b32 v52, 16, v177
  v_and_b32 v53, 0xffff0000, v176
  v_add_f32 v196, v38, v39
  v_mul_f32 v197, v38, v38
  v_fmac_f32 v197, v39, v39
  v_add_f32 v196, v196, v40
  v_fmac_f32 v197, v40, v40
  v_add_f32 v196, v196, v41
  v_fmac_f32 v197, v41, v41
  v_add_f32 v196, v196, v42
  v_fmac_f32 v197, v42, v42
  v_add_f32 v196, v196, v43
  v_fmac_f32 v197, v43, v43
  v_add_f32 v196, v196, v44
  v_fmac_f32 v197, v44, v44
  v_add_f32 v196, v196, v45
  v_fmac_f32 v197, v45, v45
  v_add_f32 v198, v46, v47
  v_mul_f32 v199, v46, v46
  v_fmac_f32 v199, v47, v47
  v_add_f32 v198, v198, v48
  v_fmac_f32 v199, v48, v48
  v_add_f32 v198, v198, v49
  v_fmac_f32 v199, v49, v49
  v_add_f32 v198, v198, v50
  v_fmac_f32 v199, v50, v50
  v_add_f32 v198, v198, v51
  v_fmac_f32 v199, v51, v51
  v_add_f32 v198, v198, v52
  v_fmac_f32 v199, v52, v52
  v_add_f32 v198, v198, v53
  v_fmac_f32 v199, v53, v53
  s_nop 0
  v_permlane32_swap_b32 v196, v198
  v_add_f32 v196, v196, v198
  v_permlane32_swap_b32 v197, v199
  v_add_f32 v197, v197, v199
  v_add_f32_dpp v196, v196, v196 quad_perm:[1,0,3,2] row_mask:0xf bank_mask:0xf
  s_nop 0
  v_add_f32_dpp v197, v197, v197 quad_perm:[1,0,3,2] row_mask:0xf bank_mask:0xf
  v_add_f32_dpp v196, v196, v196 quad_perm:[2,3,0,1] row_mask:0xf bank_mask:0xf
  s_nop 0
  v_add_f32_dpp v197, v197, v197 quad_perm:[2,3,0,1] row_mask:0xf bank_mask:0xf
  v_add_f32_dpp v196, v196, v196 row_half_mirror row_mask:0xf bank_mask:0xf
  s_nop 0
  v_add_f32_dpp v197, v197, v197 row_half_mirror row_mask:0xf bank_mask:0xf
  v_add_f32_dpp v196, v196, v196 row_mirror row_mask:0xf bank_mask:0xf
  s_nop 0
  v_add_f32_dpp v197, v197, v197 row_mirror row_mask:0xf bank_mask:0xf
  v_add_f32_dpp v196, v196, v196 row_bcast:15 row_mask:0xa bank_mask:0xf
  s_nop 0
  v_add_f32_dpp v197, v197, v197 row_bcast:15 row_mask:0xa bank_mask:0xf
  v_mul_f32 v196, 0x3b000000, v196
  v_mul_f32 v197, 0x3b000000, v197
  v_fma_f32 v197, -v196, v196, v197
  v_max_f32 v197, 0, v197
  v_add_f32 v199, 0x3727c5ac, v197
  v_rsq_f32 v199, v199
  s_nop 0
  v_mul_f32 v198, v196, v199
  v_readlane_b32 s52, v199, 16
  v_readlane_b32 s53, v199, 48
  v_readlane_b32 s54, v198, 16
  v_readlane_b32 s55, v198, 48
  s_nop 0
  v_mov_b32 v9, s54
  v_add_f32 v9, s55, v9
  v_fma_f32 v208, v38, s52, -v9
  v_fmac_f32 v208, s53, v46
  ds_bpermute_b32 v208, v12, v208
  v_fma_f32 v209, v39, s52, -v9
  v_fmac_f32 v209, s53, v47
  v_fma_f32 v210, v40, s52, -v9
  v_fmac_f32 v210, s53, v48
  v_fma_f32 v211, v41, s52, -v9
  v_fmac_f32 v211, s53, v49
  v_fma_f32 v212, v42, s52, -v9
  v_fmac_f32 v212, s53, v50
  v_fma_f32 v213, v43, s52, -v9
  v_fmac_f32 v213, s53, v51
  v_fma_f32 v214, v44, s52, -v9
  v_fmac_f32 v214, s53, v52
  v_fma_f32 v215, v45, s52, -v9
  v_fmac_f32 v215, s53, v53
  v_cndmask_b32 v216, v210, v214, s[44:45]
  v_cndmask_b32 v217, v211, v213, s[44:45]
  v_cvt_pk_f16_f32 v205, v216, v217
  v_cndmask_b32 v217, v213, v211, s[44:45]
  v_cvt_pk_f16_f32 v206, v212, v217
  v_cndmask_b32 v216, v214, v210, s[44:45]
  v_cndmask_b32 v217, v215, v209, s[44:45]
  v_cvt_pk_f16_f32 v207, v216, v217
  v_cndmask_b32 v217, v209, v215, s[44:45]
  ds_write2_b32 v13, v206, v207 offset0:8 offset1:12
  s_waitcnt lgkmcnt(1)
  v_cvt_pk_f16_f32 v204, v208, v217
  ds_write2_b32 v13, v204, v205 offset0:0 offset1:4
  s_lshl_b32 s38, s2, 13
  s_add_u32 s39, s38, 4096
  v_mov_b32 v222, s40
  v_mov_b32 v223, s40
  s_waitcnt vmcnt(0) lgkmcnt(0)
  v_mov_b32 v206, s40
  v_mov_b32 v207, s40
  s_barrier
  ds_read_b64 v[204:205], v30 offset:4096
  ds_read_b64 v[220:221], v30 offset:5120
  s_waitcnt lgkmcnt(1)
  buffer_store_dwordx4 v[204:207], v11, s[4:7], s38 offen sc0 sc1
  s_waitcnt lgkmcnt(0)
  buffer_store_dwordx4 v[220:223], v11, s[4:7], s39 offen sc0 sc1
  s_mul_i32 s36, s23, 1152
  s_add_u32 s36, s36, 0x540000
  buffer_store_dwordx4 v[188:191], v11, s[4:7], s61 offen sc0 sc1
  v_lshlrev_b32 v9, 4, v1
  buffer_store_dwordx4 v[188:191], v9, s[4:7], s36 offen sc0 sc1
  s_mov_b64 exec, 1
  buffer_store_dwordx4 v[188:191], off, s[4:7], s36 offset:1024 sc0 sc1
  s_mov_b64 exec, -1
  s_sub_u32 s36, s2, 8
  s_cmp_ge_u32 s36, 80
  s_cbranch_scc1 M_clr4
  s_mul_i32 s36, s36, 4352
  s_add_u32 s36, s36, 0xa80000
  buffer_store_dwordx4 v[188:191], v11, s[4:7], s36 offen sc0 sc1
  M_clr4:
  v_lshlrev_b32 v54, 16, v180
  v_and_b32 v55, 0xffff0000, v180
  v_lshlrev_b32 v56, 16, v181
  v_and_b32 v57, 0xffff0000, v181
  v_lshlrev_b32 v58, 16, v182
  v_and_b32 v59, 0xffff0000, v182
  v_lshlrev_b32 v60, 16, v183
  v_and_b32 v61, 0xffff0000, v183
  v_lshlrev_b32 v62, 16, v193
  v_and_b32 v63, 0xffff0000, v187
  v_lshlrev_b32 v64, 16, v187
  v_and_b32 v65, 0xffff0000, v186
  v_lshlrev_b32 v66, 16, v186
  v_and_b32 v67, 0xffff0000, v185
  v_lshlrev_b32 v68, 16, v185
  v_and_b32 v69, 0xffff0000, v184
  v_lshrrev_b32 v9, 2, v2
  v_and_b32 v10, 3, v2
  v_lshl_add_u32 v9, v9, 3, v10
  v_cvt_f32_u32 v196, v9
  v_lshlrev_b32 v9, 2, v3
  v_cvt_f32_u32 v197, v9
  s_mov_b32 s36, 0x3d000000
  s_mov_b32 s37, 0x3e800000
  v_mul_f32 v201, s36, v196
  v_mul_f32 v200, v197, v201
  v_cos_f32 v198, v200
  v_sin_f32 v199, v200
  v_mul_f32 v9, 0x3d800000, v200
  v_cvt_pk_f16_f32 v72, v198, v199
  v_cvt_pk_f16_f32 v76, -v199, v198
  v_cos_f32 v198, v9
  v_sin_f32 v199, v9
  v_mul_f32 v88, s37, v198
  v_mul_f32 v89, s37, v199
  v_add_f32 v200, v200, v201
  v_cos_f32 v198, v200
  v_sin_f32 v199, v200
  v_mul_f32 v9, 0x3d800000, v200
  v_add_f32 v9, s37, v9
  v_cvt_pk_f16_f32 v73, v198, v199
  v_cvt_pk_f16_f32 v77, -v199, v198
  v_cos_f32 v198, v9
  v_sin_f32 v199, v9
  v_mul_f32 v90, s37, v198
  v_mul_f32 v91, s37, v199
  v_add_f32 v200, v200, v201
  v_cos_f32 v198, v200
  v_sin_f32 v199, v200
  v_mul_f32 v9, 0x3d800000, v200
  v_cvt_pk_f16_f32 v74, v198, v199
  v_cvt_pk_f16_f32 v78, -v199, v198
  v_cos_f32 v198, v9
  v_sin_f32 v199, v9
  v_mul_f32 v92, s37, v198
  v_mul_f32 v93, s37, v199
  v_add_f32 v200, v200, v201
  v_cos_f32 v198, v200
  v_sin_f32 v199, v200
  v_mul_f32 v9, 0x3d800000, v200
  v_add_f32 v9, s37, v9
  v_cvt_pk_f16_f32 v75, v198, v199
  v_cvt_pk_f16_f32 v79, -v199, v198
  v_cos_f32 v198, v9
  v_sin_f32 v199, v9
  v_mul_f32 v94, s37, v198
  v_mul_f32 v95, s37, v199
  v_add_f32 v196, 4.0, v196
  v_mul_f32 v201, s36, v196
  v_mul_f32 v200, v197, v201
  v_cos_f32 v198, v200
  v_sin_f32 v199, v200
  v_mul_f32 v9, 0x3d800000, v200
  v_cvt_pk_f16_f32 v80, v198, v199
  v_cvt_pk_f16_f32 v84, -v199, v198
  v_cos_f32 v198, v9
  v_sin_f32 v199, v9
  v_mul_f32 v96, s37, v198
  v_mul_f32 v97, s37, v199
  v_add_f32 v200, v200, v201
  v_cos_f32 v198, v200
  v_sin_f32 v199, v200
  v_mul_f32 v9, 0x3d800000, v200
  v_add_f32 v9, s37, v9
  v_cvt_pk_f16_f32 v81, v198, v199
  v_cvt_pk_f16_f32 v85, -v199, v198
  v_cos_f32 v198, v9
  v_sin_f32 v199, v9
  v_mul_f32 v98, s37, v198
  v_mul_f32 v99, s37, v199
  v_add_f32 v200, v200, v201
  v_cos_f32 v198, v200
  v_sin_f32 v199, v200
  v_mul_f32 v9, 0x3d800000, v200
  v_cvt_pk_f16_f32 v82, v198, v199
  v_cvt_pk_f16_f32 v86, -v199, v198
  v_cos_f32 v198, v9
  v_sin_f32 v199, v9
  v_mul_f32 v100, s37, v198
  v_mul_f32 v101, s37, v199
  v_add_f32 v200, v200, v201
  v_cos_f32 v198, v200
  v_sin_f32 v199, v200
  v_mul_f32 v9, 0x3d800000, v200
  v_add_f32 v9, s37, v9
  v_cvt_pk_f16_f32 v83, v198, v199
  v_cvt_pk_f16_f32 v87, -v199, v198
  v_cos_f32 v198, v9
  v_sin_f32 v199, v9
  v_mul_f32 v102, s37, v198
  v_mul_f32 v103, s37, v199
  v_cvt_f32_u32 v201, v2
  v_mul_f32 v201, 0x3d800000, v201
  v_mul_f32 v200, v197, v201
  v_cos_f32 v198, v200
  v_sin_f32 v199, v200
  s_nop 0
  v_cvt_pk_f16_f32 v104, v198, v199
  v_add_f32 v200, v200, v201
  v_cos_f32 v198, v200
  v_sin_f32 v199, v200
  s_nop 0
  v_cvt_pk_f16_f32 v105, v198, v199
  v_add_f32 v200, v200, v201
  v_cos_f32 v198, v200
  v_sin_f32 v199, v200
  s_nop 0
  v_cvt_pk_f16_f32 v106, v198, v199
  v_add_f32 v200, v200, v201
  v_cos_f32 v198, v200
  v_sin_f32 v199, v200
  s_nop 0
  v_cvt_pk_f16_f32 v107, v198, v199
  v_lshrrev_b32 v9, 1, v2
  v_lshl_add_u32 v9, v3, 5, v9
  s_lshl_b32 s36, s22, 2
  s_sub_u32 s37, 2060, s36
  s_cmp_eq_u32 s23, 0
  s_cselect_b32 s37, s36, s37
  s_cmp_eq_u32 s25, 8308
  s_cselect_b32 s21, 0, -1
  v_lshl_add_u32 v15, v9, 4, s36
  v_lshl_add_u32 v16, v9, 4, s37
  v_and_b32 v9, 1, v0
  v_cmp_eq_u32 s[46:47], 1, v9
  v_mov_b32 v9, 0xbc003c00
  v_mov_b32 v10, 0x3c00bc00
  v_cndmask_b32 v17, v9, v10, s[46:47]
  v_add_f32 v18, v54, v55
  v_add_f32 v18, v18, v56
  v_add_f32 v18, v18, v57
  v_add_f32 v18, v18, v58
  v_add_f32 v18, v18, v59
  v_add_f32 v18, v18, v60
  v_add_f32 v18, v18, v61
  v_mov_b32 v9, v18
  s_nop 1
  v_permlane32_swap_b32 v18, v9
  v_add_f32 v18, v18, v9
  s_nop 1
  v_add_f32_dpp v18, v18, v18 quad_perm:[1,0,3,2] row_mask:0xf bank_mask:0xf
  s_nop 1
  v_add_f32_dpp v18, v18, v18 quad_perm:[2,3,0,1] row_mask:0xf bank_mask:0xf
  s_nop 1
  v_add_f32_dpp v18, v18, v18 row_half_mirror row_mask:0xf bank_mask:0xf
  s_nop 1
  v_add_f32_dpp v18, v18, v18 row_mirror row_mask:0xf bank_mask:0xf
  s_nop 1
  v_add_f32_dpp v18, v18, v18 row_bcast:15 row_mask:0xa bank_mask:0xf
  s_waitcnt vmcnt(0)
  s_lshl_b32 s48, s3, 6
  s_add_u32 s49, s48, 0x80000
  s_add_u32 s50, s48, 0x100000
  s_add_u32 s51, s48, 0x180000
  s_add_u32 s52, s48, 0x200000
  s_cmp_lg_u32 s22, 3
  s_cbranch_scc1 M_e14
  buffer_load_dwordx3 v[188:190], off, s[4:7], s52 sc0 sc1
  M_e14:
  s_mov_b32 s37, 0x10000
M_gq1:
  buffer_load_dwordx3 v[172:174], v28, s[4:7], s48 offen sc0 sc1
  buffer_load_dwordx3 v[176:178], v28, s[4:7], s49 offen sc0 sc1
  buffer_load_dwordx3 v[180:182], v28, s[4:7], s50 offen sc0 sc1
  buffer_load_dwordx3 v[184:186], v28, s[4:7], s51 offen sc0 sc1
  s_sub_u32 s37, s37, 1
  s_waitcnt vmcnt(0)
  v_bitop3_b32 v9, v174, v178, s40 bitop3:0x7e
  v_bitop3_b32 v9, v9, v182, s40 bitop3:0xf6
  v_bitop3_b32 v9, v9, v186, s40 bitop3:0xf6
  v_cmp_ne_u32 vcc, 0, v9
  s_cbranch_scc1 M_gq1x
  s_mov_b64 exec, vcc
  s_cbranch_vccnz M_gq1
M_gq1x:
  s_mov_b64 exec, -1
  ds_write2_b32 v22, v172, v173 offset0:0 offset1:1
  ds_write_b64 v23, v[176:177] offset:12544
  ds_write_b64 v24, v[180:181] offset:12544
  ds_write_b64 v25, v[184:185] offset:12544
  s_cmp_lg_u32 s22, 3
  s_cbranch_scc1 M_e24
  s_mov_b32 s37, 0x10000
  s_branch M_gx4c
M_gx4:
  buffer_load_dwordx3 v[188:190], off, s[4:7], s52 sc0 sc1
M_gx4c:
  s_sub_u32 s37, s37, 1
  s_waitcnt vmcnt(0)
  v_cmp_ne_u32 vcc, s40, v190
  s_cbranch_scc1 M_gx4x
  s_mov_b64 exec, vcc
  s_cbranch_vccnz M_gx4
M_gx4x:
  s_mov_b64 exec, 1
  ds_write_b32 v19, v188 offset:12608
  s_mov_b64 exec, -1
  M_e24:
  s_cmp_eq_u32 s2, 256
  s_waitcnt lgkmcnt(0)
  s_barrier
  s_cbranch_scc1 M_cx4
  ds_read_b128 v[172:175], v19 offset:12544
  ds_read_b128 v[176:179], v19 offset:12560
  ds_read_b128 v[180:183], v19 offset:17152
  ds_read_b128 v[184:187], v19 offset:17168
  ds_read_b128 v[188:191], v19 offset:14848
  ds_read_b128 v[192:195], v19 offset:14864
  ds_read_b128 v[196:199], v19 offset:19456
  ds_read_b128 v[200:203], v19 offset:19472
  s_waitcnt lgkmcnt(7)
  v_mfma_f32_16x16x32_f16 v[204:207], v[172:175], v[108:111], 0
  v_mfma_f32_16x16x32_f16 v[208:211], v[172:175], v[112:115], 0
  s_waitcnt lgkmcnt(6)
  v_mfma_f32_16x16x32_f16 v[204:207], v[176:179], v[116:119], v[204:207]
  v_mfma_f32_16x16x32_f16 v[208:211], v[176:179], v[120:123], v[208:211]
  s_waitcnt lgkmcnt(5)
  v_mfma_f32_16x16x32_f16 v[204:207], v[180:183], v[124:127], v[204:207]
  v_mfma_f32_16x16x32_f16 v[208:211], v[180:183], v[128:131], v[208:211]
  s_waitcnt lgkmcnt(4)
  v_mfma_f32_16x16x32_f16 v[204:207], v[184:187], v[132:135], v[204:207]
  v_mfma_f32_16x16x32_f16 v[208:211], v[184:187], v[136:139], v[208:211]
  s_waitcnt lgkmcnt(3)
  v_mfma_f32_16x16x32_f16 v[212:215], v[188:191], v[108:111], 0
  v_mfma_f32_16x16x32_f16 v[216:219], v[188:191], v[112:115], 0
  s_waitcnt lgkmcnt(2)
  v_mfma_f32_16x16x32_f16 v[212:215], v[192:195], v[116:119], v[212:215]
  v_mfma_f32_16x16x32_f16 v[216:219], v[192:195], v[120:123], v[216:219]
  s_waitcnt lgkmcnt(1)
  v_mfma_f32_16x16x32_f16 v[212:215], v[196:199], v[124:127], v[212:215]
  v_mfma_f32_16x16x32_f16 v[216:219], v[196:199], v[128:131], v[216:219]
  s_waitcnt lgkmcnt(0)
  v_mfma_f32_16x16x32_f16 v[212:215], v[200:203], v[132:135], v[212:215]
  v_mfma_f32_16x16x32_f16 v[216:219], v[200:203], v[136:139], v[216:219]
  v_mul_f32 v9, v204, v140
  v_mul_f32 v10, v208, v140
  v_fmac_f32 v9, v208, v141
  v_fma_f32 v10, -v204, v141, v10
  v_cvt_pk_f16_f32 v220, v9, v10
  v_mul_f32 v9, v205, v142
  v_mul_f32 v10, v209, v142
  v_fmac_f32 v9, v209, v143
  v_fma_f32 v10, -v205, v143, v10
  v_cvt_pk_f16_f32 v221, v9, v10
  v_mul_f32 v9, v206, v144
  v_mul_f32 v10, v210, v144
  v_fmac_f32 v9, v210, v145
  v_fma_f32 v10, -v206, v145, v10
  v_cvt_pk_f16_f32 v222, v9, v10
  v_mul_f32 v9, v207, v146
  v_mul_f32 v10, v211, v146
  v_fmac_f32 v9, v211, v147
  v_fma_f32 v10, -v207, v147, v10
  v_cvt_pk_f16_f32 v223, v9, v10
  s_nop 1
  v_mfma_f32_16x16x32_f16 v[228:231], v[156:159], v[220:223], 0
  v_mfma_f32_16x16x32_f16 v[232:235], v[164:167], v[220:223], 0
  v_mul_f32 v9, v212, v148
  v_mul_f32 v10, v216, v148
  v_fmac_f32 v9, v216, v149
  v_fma_f32 v10, -v212, v149, v10
  v_cvt_pk_f16_f32 v224, v9, v10
  v_mul_f32 v9, v213, v150
  v_mul_f32 v10, v217, v150
  v_fmac_f32 v9, v217, v151
  v_fma_f32 v10, -v213, v151, v10
  v_cvt_pk_f16_f32 v225, v9, v10
  v_mul_f32 v9, v214, v152
  v_mul_f32 v10, v218, v152
  v_fmac_f32 v9, v218, v153
  v_fma_f32 v10, -v214, v153, v10
  v_cvt_pk_f16_f32 v226, v9, v10
  v_mul_f32 v9, v215, v154
  v_mul_f32 v10, v219, v154
  v_fmac_f32 v9, v219, v155
  v_fma_f32 v10, -v215, v155, v10
  v_cvt_pk_f16_f32 v227, v9, v10
  s_nop 1
  v_mfma_f32_16x16x32_f16 v[228:231], v[160:163], v[224:227], v[228:231]
  v_mfma_f32_16x16x32_f16 v[232:235], v[168:171], v[224:227], v[232:235]
  s_add_u32 s36, s41, 0x320000
  s_waitcnt vmcnt(0)
  s_nop 5
  v_cvt_pk_f16_f32 v172, v228, v232
  v_cvt_pk_f16_f32 v173, v229, v233
  v_cvt_pk_f16_f32 v174, v230, v234
  v_cvt_pk_f16_f32 v175, v231, v235
  buffer_store_dwordx4 v[172:175], v20, s[4:7], s36 offen sc0 sc1
  v_mov_b32 v176, -1
  v_mov_b32 v177, -1
  v_mov_b32 v178, -1
  v_mov_b32 v179, -1
  s_add_u32 s37, s41, 0x430000
  buffer_store_dwordx4 v[176:179], v20, s[4:7], s37 offen sc0 sc1
  s_branch M_cy4
  ST4:
  s_branch ST10
  M_cx4:
  s_sleep 8
  s_waitcnt vmcnt(0)
  M_cy4:
  s_add_u32 s38, s25, 0x320000
  s_waitcnt vmcnt(0)
  s_mov_b32 s37, 0x10000
M_gua:
  buffer_load_dwordx4 v[172:175], v8, s[4:7], s38 offen sc0 sc1
  s_sub_u32 s37, s37, 1
  s_waitcnt vmcnt(0)
  v_and_b32 v175, s21, v175
  v_max_u32 v9, v172, v173
  v_max3_u32 v9, v9, v174, v175
  v_cmp_eq_u32 vcc, -1, v9
  s_cbranch_scc1 M_guax
  s_mov_b64 exec, vcc
  s_cbranch_vccnz M_gua
M_guax:
  s_mov_b64 exec, -1
  ds_write_b128 v11, v[172:175] offset:0
  s_waitcnt lgkmcnt(0)
  s_barrier
  ds_read2_b32 v[172:173], v15 offset0:0 offset1:32
  ds_read2_b32 v[176:177], v16 offset0:0 offset1:32
  ds_read2_b32 v[174:175], v15 offset0:64 offset1:96
  ds_read2_b32 v[178:179], v16 offset0:64 offset1:96
  s_waitcnt lgkmcnt(0)
  v_pk_fma_f16 v172, v176, v17, v172
  v_pk_fma_f16 v173, v177, v17, v173
  v_pk_fma_f16 v174, v178, v17, v174
  v_pk_fma_f16 v175, v179, v17, v175
  s_cmp_lg_u32 s60, 0
  s_cbranch_scc1 M_nokey3
  v_mfma_f32_16x16x32_f16 v[180:183], v[172:175], v[72:75], 0
  v_mfma_f32_16x16x32_f16 v[184:187], v[172:175], v[76:79], 0
  v_mfma_f32_16x16x32_f16 v[188:191], v[172:175], v[80:83], 0
  v_mfma_f32_16x16x32_f16 v[192:195], v[172:175], v[84:87], 0
  v_cvt_f32_f16 v10, v172
  s_mov_b32 s54, 0x41800000
  v_readlane_b32 s52, v10, 0
  s_nop 1
  v_mul_f32 v9, v180, v88
  v_mul_f32 v10, v184, v88
  v_fmac_f32 v9, v184, v89
  v_fma_f32 v10, -v180, v89, v10
  v_cvt_pk_f16_f32 v196, v9, v10
  v_mul_f32 v9, v181, v90
  v_mul_f32 v10, v185, v90
  v_fmac_f32 v9, v185, v91
  v_fma_f32 v10, -v181, v91, v10
  v_cvt_pk_f16_f32 v197, v9, v10
  v_mul_f32 v9, v182, v92
  v_mul_f32 v10, v186, v92
  v_fmac_f32 v9, v186, v93
  v_fma_f32 v10, -v182, v93, v10
  v_cvt_pk_f16_f32 v198, v9, v10
  v_mul_f32 v9, v183, v94
  v_mul_f32 v10, v187, v94
  v_fmac_f32 v9, v187, v95
  v_fma_f32 v10, -v183, v95, v10
  v_cvt_pk_f16_f32 v199, v9, v10
  s_nop 1
  v_mfma_f32_16x16x32_f16 v[204:207], v[196:199], v[104:107], 0
  v_mul_f32 v9, v188, v96
  v_mul_f32 v10, v192, v96
  v_fmac_f32 v9, v192, v97
  v_fma_f32 v10, -v188, v97, v10
  v_cvt_pk_f16_f32 v200, v9, v10
  v_mul_f32 v9, v189, v98
  v_mul_f32 v10, v193, v98
  v_fmac_f32 v9, v193, v99
  v_fma_f32 v10, -v189, v99, v10
  v_cvt_pk_f16_f32 v201, v9, v10
  v_mul_f32 v9, v190, v100
  v_mul_f32 v10, v194, v100
  v_fmac_f32 v9, v194, v101
  v_fma_f32 v10, -v190, v101, v10
  v_cvt_pk_f16_f32 v202, v9, v10
  v_mul_f32 v9, v191, v102
  v_mul_f32 v10, v195, v102
  v_fmac_f32 v9, v195, v103
  v_fma_f32 v10, -v191, v103, v10
  v_cvt_pk_f16_f32 v203, v9, v10
  s_nop 1
  v_mfma_f32_16x16x32_f16 v[208:211], v[200:203], v[104:107], 0
  v_readlane_b32 s53, v204, 0
  v_mov_b32 v10, s52
  v_mul_f32 v10, -4.0, v10
  v_mov_b32 v9, s53
  v_mul_f32 v9, 0xc1800000, v9
  v_add_f32 v10, v10, v9
  v_fma_f32 v204, v204, s54, v9
  v_add_f32 v38, v38, v204
  v_add_f32 v46, v46, v204
  v_fma_f32 v205, v205, s54, v10
  v_add_f32 v39, v39, v205
  v_add_f32 v47, v47, v205
  v_fma_f32 v206, v206, s54, v9
  v_add_f32 v40, v40, v206
  v_add_f32 v48, v48, v206
  v_fma_f32 v207, v207, s54, v10
  v_add_f32 v41, v41, v207
  v_add_f32 v49, v49, v207
  v_fma_f32 v208, v208, s54, v9
  v_add_f32 v42, v42, v208
  v_add_f32 v50, v50, v208
  v_fma_f32 v209, v209, s54, v10
  v_add_f32 v43, v43, v209
  v_add_f32 v51, v51, v209
  v_fma_f32 v210, v210, s54, v9
  v_add_f32 v44, v44, v210
  v_add_f32 v52, v52, v210
  v_fma_f32 v211, v211, s54, v10
  v_add_f32 v45, v45, v211
  v_add_f32 v53, v53, v211
  v_add_f32 v196, v38, v39
  v_mul_f32 v197, v38, v38
  v_mul_f32 v200, v38, v54
  v_fmac_f32 v197, v39, v39
  v_fmac_f32 v200, v39, v55
  v_add_f32 v196, v196, v40
  v_fmac_f32 v197, v40, v40
  v_fmac_f32 v200, v40, v56
  v_add_f32 v196, v196, v41
  v_fmac_f32 v197, v41, v41
  v_fmac_f32 v200, v41, v57
  v_add_f32 v196, v196, v42
  v_fmac_f32 v197, v42, v42
  v_fmac_f32 v200, v42, v58
  v_add_f32 v196, v196, v43
  v_fmac_f32 v197, v43, v43
  v_fmac_f32 v200, v43, v59
  v_add_f32 v196, v196, v44
  v_fmac_f32 v197, v44, v44
  v_fmac_f32 v200, v44, v60
  v_add_f32 v196, v196, v45
  v_fmac_f32 v197, v45, v45
  v_fmac_f32 v200, v45, v61
  v_add_f32 v198, v46, v47
  v_mul_f32 v199, v46, v46
  v_mul_f32 v201, v46, v62
  v_fmac_f32 v199, v47, v47
  v_fmac_f32 v201, v47, v63
  v_add_f32 v198, v198, v48
  v_fmac_f32 v199, v48, v48
  v_fmac_f32 v201, v48, v64
  v_add_f32 v198, v198, v49
  v_fmac_f32 v199, v49, v49
  v_fmac_f32 v201, v49, v65
  v_add_f32 v198, v198, v50
  v_fmac_f32 v199, v50, v50
  v_fmac_f32 v201, v50, v66
  v_add_f32 v198, v198, v51
  v_fmac_f32 v199, v51, v51
  v_fmac_f32 v201, v51, v67
  v_add_f32 v198, v198, v52
  v_fmac_f32 v199, v52, v52
  v_fmac_f32 v201, v52, v68
  v_add_f32 v198, v198, v53
  v_fmac_f32 v199, v53, v53
  v_fmac_f32 v201, v53, v69
  v_permlane32_swap_b32 v196, v198
  v_add_f32 v196, v196, v198
  v_permlane32_swap_b32 v197, v199
  v_add_f32 v197, v197, v199
  v_permlane32_swap_b32 v200, v201
  v_add_f32 v200, v200, v201
  v_add_f32_dpp v196, v196, v196 quad_perm:[1,0,3,2] row_mask:0xf bank_mask:0xf
  v_add_f32_dpp v197, v197, v197 quad_perm:[1,0,3,2] row_mask:0xf bank_mask:0xf
  v_add_f32_dpp v200, v200, v200 quad_perm:[1,0,3,2] row_mask:0xf bank_mask:0xf
  v_add_f32_dpp v196, v196, v196 quad_perm:[2,3,0,1] row_mask:0xf bank_mask:0xf
  v_add_f32_dpp v197, v197, v197 quad_perm:[2,3,0,1] row_mask:0xf bank_mask:0xf
  v_add_f32_dpp v200, v200, v200 quad_perm:[2,3,0,1] row_mask:0xf bank_mask:0xf
  v_add_f32_dpp v196, v196, v196 row_half_mirror row_mask:0xf bank_mask:0xf
  v_add_f32_dpp v197, v197, v197 row_half_mirror row_mask:0xf bank_mask:0xf
  v_add_f32_dpp v200, v200, v200 row_half_mirror row_mask:0xf bank_mask:0xf
  v_add_f32_dpp v196, v196, v196 row_mirror row_mask:0xf bank_mask:0xf
  v_add_f32_dpp v197, v197, v197 row_mirror row_mask:0xf bank_mask:0xf
  v_add_f32_dpp v200, v200, v200 row_mirror row_mask:0xf bank_mask:0xf
  v_add_f32_dpp v196, v196, v196 row_bcast:15 row_mask:0xa bank_mask:0xf
  v_add_f32_dpp v197, v197, v197 row_bcast:15 row_mask:0xa bank_mask:0xf
  v_add_f32_dpp v200, v200, v200 row_bcast:15 row_mask:0xa bank_mask:0xf
  v_mul_f32 v196, 0x3b000000, v196
  v_mul_f32 v197, 0x3b000000, v197
  v_fma_f32 v197, -v196, v196, v197
  v_max_f32 v197, 0, v197
  v_add_f32 v199, 0x3727c5ac, v197
  v_rsq_f32 v199, v199
  s_nop 0
  v_add_f32 v208, 1.0, v199
  v_fma_f32 v200, -v196, v18, v200
  v_mul_f32 v209, v196, v199
  v_mul_f32 v197, v197, v208
  v_rcp_f32 v205, v208
  v_mul_f32 v197, v197, v208
  v_mul_f32 v206, v200, v199
  v_add_f32 v197, 0x3727c5ac, v197
  v_mov_b32 v204, v196
  v_rsq_f32 v207, v197
  v_mul_f32 v205, v205, v199
  v_readlane_b32 s48, v208, 16
  v_readlane_b32 s49, v208, 48
  v_readlane_b32 s50, v209, 16
  v_readlane_b32 s51, v209, 48
  v_mul_f32 v210, v207, v208
  v_and_b32 v9, 32, v0
  v_ashrrev_i32 v208, 31, v206
  v_lshl_add_u32 v9, v9, 6, s23
  v_or_b32 v208, 0x80000000, v208
  v_lshrrev_b32 v10, 3, v0
  v_xor_b32 v208, v208, v206
  v_and_b32 v10, 60, v10
  v_and_b32 v208, 0xfffff000, v208
  s_cmp_eq_u32 s23, s24
  s_cselect_b32 s36, 0, 0x10000
  v_or_b32 v208, v208, v9
  s_cmp_lg_u32 s60, 0
  s_cbranch_scc1 M_nokey3
  s_mov_b32 exec_lo, 0x10000
  s_mov_b32 exec_hi, s36
  ds_write_b32 v10, v208 offset:8192
  s_mov_b64 exec, -1
  M_nokey3:
  v_lshlrev_b32 v9, 2, v2
  v_mov_b32 v34, 0
  v_mov_b32 v32, s40
  s_lshl_b32 s38, s2, 7
  s_add_u32 s38, s38, 0x790000
  s_and_b32 s39, s2, 7
  s_lshl_b32 s39, s39, 5
  s_bfe_u32 s37, s2, 0x50003
  s_add_u32 s39, s39, s37
  s_and_b32 s37, s2, 256
  s_add_u32 s39, s39, s37
  s_mul_i32 s39, s39, 16
  s_add_u32 s39, s39, 0x800000
  s_mul_i32 s37, s22, 135168
  s_add_u32 s39, s39, s37
  v_lshrrev_b32 v239, 1, v1
  v_and_b32 v239, 24, v239
  v_and_or_b32 v239, v1, 7, v239
  v_mul_u32_u24 v239, 4224, v239
  s_waitcnt lgkmcnt(0)
  s_barrier
  ds_read_b32 v33, v9 offset:8192
  s_waitcnt lgkmcnt(0)
  v_mov_b32_dpp v237, v33 quad_perm:[1,0,3,2] row_mask:0xf bank_mask:0xf
  v_mov_b32_dpp v238, v34 quad_perm:[1,0,3,2] row_mask:0xf bank_mask:0xf
  v_max_u32 v34, v34, v238
  v_med3_u32 v34, v33, v34, v237
  v_max_u32 v33, v33, v237
  s_nop 1
  v_mov_b32_dpp v237, v33 quad_perm:[2,3,0,1] row_mask:0xf bank_mask:0xf
  v_mov_b32_dpp v238, v34 quad_perm:[2,3,0,1] row_mask:0xf bank_mask:0xf
  v_max_u32 v34, v34, v238
  v_med3_u32 v34, v33, v34, v237
  v_max_u32 v33, v33, v237
  s_nop 1
  v_mov_b32_dpp v237, v33 row_half_mirror row_mask:0xf bank_mask:0xf
  v_mov_b32_dpp v238, v34 row_half_mirror row_mask:0xf bank_mask:0xf
  v_max_u32 v34, v34, v238
  v_med3_u32 v34, v33, v34, v237
  v_max_u32 v33, v33, v237
  s_cmp_ge_u32 s22, 1
  s_cbranch_scc1 M_nopub3
  s_mov_b64 exec, 15
  buffer_store_dwordx4 v[32:35], v239, s[4:7], s39 offen sc0 sc1
  s_mov_b64 exec, -1
  M_nopub3:
  s_lshr_b32 s36, s2, 3
  s_or_b32 s36, s36, s22
  s_cbranch_scc1 M_hu1
  s_lshl_b32 s36, s2, 7
  s_add_u32 s36, s36, 0x7c0000
  v_mov_b32 v9, s40
  s_mov_b64 exec, 1
  buffer_store_dword v9, off, s[4:7], s36 sc0 sc1
  s_mov_b64 exec, -1
  M_hu1:
  s_lshr_b32 s36, s2, 8
  s_mul_i32 s36, s36, 60
  s_memrealtime s[96:97]
  s_waitcnt lgkmcnt(0)
  s_sub_u32 s96, s96, s36
  s_cmp_lg_u32 s60, 0
  s_cbranch_scc1 M_cd31
  v_mul_f32 v198, v196, v210
  v_readlane_b32 s52, v210, 16
  v_readlane_b32 s53, v210, 48
  v_readlane_b32 s54, v198, 16
  v_readlane_b32 s55, v198, 48
  s_nop 0
  v_mov_b32 v9, s54
  v_add_f32 v9, s55, v9
  v_fma_f32 v216, v38, s52, -v9
  v_fmac_f32 v216, s53, v46
  ds_bpermute_b32 v216, v12, v216
  v_fma_f32 v217, v39, s52, -v9
  v_fmac_f32 v217, s53, v47
  v_fma_f32 v218, v40, s52, -v9
  v_fmac_f32 v218, s53, v48
  v_fma_f32 v219, v41, s52, -v9
  v_fmac_f32 v219, s53, v49
  v_fma_f32 v220, v42, s52, -v9
  v_fmac_f32 v220, s53, v50
  v_fma_f32 v221, v43, s52, -v9
  v_fmac_f32 v221, s53, v51
  v_fma_f32 v222, v44, s52, -v9
  v_fmac_f32 v222, s53, v52
  v_fma_f32 v223, v45, s52, -v9
  v_fmac_f32 v223, s53, v53
  v_cndmask_b32 v224, v218, v222, s[44:45]
  v_cndmask_b32 v225, v219, v221, s[44:45]
  v_cvt_pk_f16_f32 v213, v224, v225
  v_cndmask_b32 v225, v221, v219, s[44:45]
  v_cvt_pk_f16_f32 v214, v220, v225
  v_cndmask_b32 v224, v222, v218, s[44:45]
  v_cndmask_b32 v225, v223, v217, s[44:45]
  v_cvt_pk_f16_f32 v215, v224, v225
  v_cndmask_b32 v225, v217, v223, s[44:45]
  ds_write2_b32 v13, v214, v215 offset0:8 offset1:12
  s_waitcnt lgkmcnt(1)
  v_cvt_pk_f16_f32 v212, v216, v225
  ds_write2_b32 v13, v212, v213 offset0:0 offset1:4
  v_readfirstlane_b32 s52, v33
  v_readfirstlane_b32 s53, v34
  v_mov_b32 v9, s50
  v_mov_b32 v10, s51
  v_fma_f32 v46, v46, s49, -v10
  ds_bpermute_b32 v236, v14, v46
  v_fma_f32 v47, v47, s49, -v10
  v_fma_f32 v48, v48, s49, -v10
  v_fma_f32 v49, v49, s49, -v10
  v_fma_f32 v50, v50, s49, -v10
  v_fma_f32 v51, v51, s49, -v10
  v_fma_f32 v52, v52, s49, -v10
  v_fma_f32 v53, v53, s49, -v10
  v_fma_f32 v38, v38, s48, -v9
  v_fma_f32 v39, v39, s48, -v9
  v_fma_f32 v40, v40, s48, -v9
  v_fma_f32 v41, v41, s48, -v9
  v_fma_f32 v42, v42, s48, -v9
  v_fma_f32 v43, v43, s48, -v9
  v_fma_f32 v44, v44, s48, -v9
  v_fma_f32 v45, v45, s48, -v9
  v_cvt_pk_bf16_f32 v228, v38, v39
  v_cvt_pk_bf16_f32 v229, v40, v41
  v_cvt_pk_bf16_f32 v230, v42, v43
  v_cvt_pk_bf16_f32 v231, v44, v45
  v_cvt_pk_bf16_f32 v233, v52, v51
  v_cvt_pk_bf16_f32 v234, v50, v49
  v_cvt_pk_bf16_f32 v235, v48, v47
  s_lshl_b32 s36, s22, 11
  v_add_u32 v9, s36, v5
  v_add_u32 v10, s36, v6
  ds_write_b128 v9, v[228:231] offset:23808
  v_lshl_add_u32 v9, v1, 4, s36
  s_waitcnt lgkmcnt(1)
  v_cvt_pk_bf16_f32 v232, v236, v53
  ds_write_b128 v10, v[232:235] offset:24832
  v_lshlrev_b32 v236, 4, v1
  ds_read_b128 v[228:231], v9 offset:23808
  ds_read_b128 v[232:235], v9 offset:24832
  s_and_b32 s36, s23, 0x73f
  s_mul_i32 s36, s36, 1152
  s_add_u32 s36, s36, 0x540000
  s_mov_b32 s54, 0
  s_waitcnt lgkmcnt(0)
  s_and_b32 s37, s52, 2047
  s_cmp_lg_u32 s37, s23
  s_cbranch_scc1 M_cd30
  s_bitcmp1_b32 s52, 11
  s_cbranch_scc1 M_cb30
  buffer_store_dwordx4 v[228:231], v236, s[4:7], s36 offen sc0 sc1
  s_mov_b64 exec, 0x10000
  s_bitset1_b32 s54, 0
  s_branch M_cs30
  M_cb30:
  buffer_store_dwordx4 v[232:235], v236, s[4:7], s36 offen sc0 sc1
  s_mov_b32 exec_lo, 0
  s_mov_b32 exec_hi, 0x10000
  s_bitset1_b32 s54, 1
  M_cs30:
  buffer_store_dwordx4 v[204:207], off, s[4:7], s36 offset:1024 sc0 sc1
  s_mov_b64 exec, -1
  M_cd30:
  s_add_u32 s36, s36, 73728
  s_and_b32 s37, s53, 2047
  s_cmp_lg_u32 s37, s23
  s_cbranch_scc1 M_cd31
  s_bitcmp1_b32 s53, 11
  s_cbranch_scc1 M_cb31
  buffer_store_dwordx4 v[228:231], v236, s[4:7], s36 offen sc0 sc1
  s_mov_b64 exec, 0x10000
  s_bitset1_b32 s54, 0
  s_branch M_cs31
  M_cb31:
  buffer_store_dwordx4 v[232:235], v236, s[4:7], s36 offen sc0 sc1
  s_mov_b32 exec_lo, 0
  s_mov_b32 exec_hi, 0x10000
  s_bitset1_b32 s54, 1
  M_cs31:
  buffer_store_dwordx4 v[204:207], off, s[4:7], s36 offset:1024 sc0 sc1
  s_mov_b64 exec, -1
  M_cd31:
  s_barrier
  s_sleep 10
  ds_read_b128 v[212:215], v31 offset:4096
  s_waitcnt lgkmcnt(0)
  buffer_store_dwordx4 v[212:215], v11, s[4:7], s61 offen sc0 sc1
WENDA:
  s_and_b32 s36, s20, 31
  s_cbranch_scc1 M_nospec
  s_xor_b32 s36, s20, 32
  s_lshl_b32 s36, s36, 4
  s_add_u32 s36, s36, 0x320010
  s_mov_b32 s37, 0x10000
M_gsp:
  buffer_load_dword v172, v8, s[4:7], s36 offen sc0 sc1
  s_sub_u32 s37, s37, 1
  s_waitcnt vmcnt(0)
  v_cmp_eq_u32 vcc, -1, v172
  s_cbranch_scc1 M_gspx
  s_mov_b64 exec, vcc
  s_cbranch_vccnz M_gsp
M_gspx:
  s_mov_b64 exec, -1
  s_barrier
  M_nospec:
  s_waitcnt vmcnt(0)
  s_mov_b32 s37, 64
  M_wq10:
  s_memrealtime s[98:99]
  s_sub_u32 s37, s37, 1
  s_cbranch_scc1 M_wq10x
  s_waitcnt lgkmcnt(0)
  s_sub_u32 s98, s98, s96
  s_cmp_ge_u32 s98, 150
  s_cbranch_scc1 M_wq10x
  s_sleep 2
  s_branch M_wq10
  M_wq10x:
  s_lshl_b32 s48, s3, 5
  s_add_u32 s48, s48, 0x210000
  s_add_u32 s49, s48, 0x80000
  s_add_u32 s50, s48, 0x100000
  s_cmp_lg_u32 s22, 3
  s_cbranch_scc1 M_e110
  buffer_load_dword v188, off, s[4:7], s50 sc0 sc1
  M_e110:
  s_mov_b32 s37, 0x10000
M_gq2:
  buffer_load_dwordx4 v[172:175], v29, s[4:7], s48 offen sc0 sc1
  buffer_load_dwordx4 v[176:179], v29, s[4:7], s49 offen sc0 sc1
  s_sub_u32 s37, s37, 1
  s_waitcnt vmcnt(0)
  v_max_u32 v9, v172, v176
  v_cmp_eq_u32 vcc, -1, v9
  s_cbranch_scc1 M_gq2x
  s_mov_b64 exec, vcc
  s_cbranch_vccnz M_gq2
M_gq2x:
  s_mov_b64 exec, -1
  ds_write2_b32 v26, v172, v173 offset0:0 offset1:1
  ds_write2_b32 v26, v174, v175 offset0:2 offset1:3
  ds_write_b128 v27, v[176:179] offset:12544
  s_cmp_lg_u32 s22, 3
  s_cbranch_scc1 M_e210
  s_mov_b32 s37, 0x10000
  s_branch M_gx10c
M_gx10:
  buffer_load_dword v188, off, s[4:7], s50 sc0 sc1
M_gx10c:
  s_sub_u32 s37, s37, 1
  s_waitcnt vmcnt(0)
  v_cmp_eq_u32 vcc, -1, v188
  s_cbranch_scc1 M_gx10x
  s_mov_b64 exec, vcc
  s_cbranch_vccnz M_gx10
M_gx10x:
  s_mov_b64 exec, 1
  ds_write_b32 v19, v188 offset:12608
  s_mov_b64 exec, -1
  M_e210:
  v_mul_u32_u24 v10, 16, v0
  s_and_b32 s36, s2, 3
  s_mul_i32 s36, s36, 4224
  s_add_u32 s36, s36, 0x800000
  s_add_u32 s38, s36, 4096
  buffer_load_dwordx2 v[36:37], off, s[4:7], s38 sc0 sc1
  buffer_load_dwordx3 v[32:34], v10, s[4:7], s36 offen sc0 sc1
  s_cmp_eq_u32 s2, 256
  s_waitcnt lgkmcnt(0)
  s_barrier
  s_cbranch_scc1 M_cx10
  ds_read_b128 v[172:175], v19 offset:12544
  ds_read_b128 v[176:179], v19 offset:12560
  ds_read_b128 v[180:183], v19 offset:17152
  ds_read_b128 v[184:187], v19 offset:17168
  ds_read_b128 v[188:191], v19 offset:14848
  ds_read_b128 v[192:195], v19 offset:14864
  ds_read_b128 v[196:199], v19 offset:19456
  ds_read_b128 v[200:203], v19 offset:19472
  s_waitcnt lgkmcnt(7)
  v_mfma_f32_16x16x32_f16 v[204:207], v[172:175], v[108:111], 0
  v_mfma_f32_16x16x32_f16 v[208:211], v[172:175], v[112:115], 0
  s_waitcnt lgkmcnt(6)
  v_mfma_f32_16x16x32_f16 v[204:207], v[176:179], v[116:119], v[204:207]
  v_mfma_f32_16x16x32_f16 v[208:211], v[176:179], v[120:123], v[208:211]
  s_waitcnt lgkmcnt(5)
  v_mfma_f32_16x16x32_f16 v[204:207], v[180:183], v[124:127], v[204:207]
  v_mfma_f32_16x16x32_f16 v[208:211], v[180:183], v[128:131], v[208:211]
  s_waitcnt lgkmcnt(4)
  v_mfma_f32_16x16x32_f16 v[204:207], v[184:187], v[132:135], v[204:207]
  v_mfma_f32_16x16x32_f16 v[208:211], v[184:187], v[136:139], v[208:211]
  s_waitcnt lgkmcnt(3)
  v_mfma_f32_16x16x32_f16 v[212:215], v[188:191], v[108:111], 0
  v_mfma_f32_16x16x32_f16 v[216:219], v[188:191], v[112:115], 0
  s_waitcnt lgkmcnt(2)
  v_mfma_f32_16x16x32_f16 v[212:215], v[192:195], v[116:119], v[212:215]
  v_mfma_f32_16x16x32_f16 v[216:219], v[192:195], v[120:123], v[216:219]
  s_waitcnt lgkmcnt(1)
  v_mfma_f32_16x16x32_f16 v[212:215], v[196:199], v[124:127], v[212:215]
  v_mfma_f32_16x16x32_f16 v[216:219], v[196:199], v[128:131], v[216:219]
  s_waitcnt lgkmcnt(0)
  v_mfma_f32_16x16x32_f16 v[212:215], v[200:203], v[132:135], v[212:215]
  v_mfma_f32_16x16x32_f16 v[216:219], v[200:203], v[136:139], v[216:219]
  v_mul_f32 v9, v204, v140
  v_mul_f32 v10, v208, v140
  v_fmac_f32 v9, v208, v141
  v_fma_f32 v10, -v204, v141, v10
  v_cvt_pk_f16_f32 v220, v9, v10
  v_mul_f32 v9, v205, v142
  v_mul_f32 v10, v209, v142
  v_fmac_f32 v9, v209, v143
  v_fma_f32 v10, -v205, v143, v10
  v_cvt_pk_f16_f32 v221, v9, v10
  v_mul_f32 v9, v206, v144
  v_mul_f32 v10, v210, v144
  v_fmac_f32 v9, v210, v145
  v_fma_f32 v10, -v206, v145, v10
  v_cvt_pk_f16_f32 v222, v9, v10
  v_mul_f32 v9, v207, v146
  v_mul_f32 v10, v211, v146
  v_fmac_f32 v9, v211, v147
  v_fma_f32 v10, -v207, v147, v10
  v_cvt_pk_f16_f32 v223, v9, v10
  s_nop 1
  v_mfma_f32_16x16x32_f16 v[228:231], v[156:159], v[220:223], 0
  v_mfma_f32_16x16x32_f16 v[232:235], v[164:167], v[220:223], 0
  v_mul_f32 v9, v212, v148
  v_mul_f32 v10, v216, v148
  v_fmac_f32 v9, v216, v149
  v_fma_f32 v10, -v212, v149, v10
  v_cvt_pk_f16_f32 v224, v9, v10
  v_mul_f32 v9, v213, v150
  v_mul_f32 v10, v217, v150
  v_fmac_f32 v9, v217, v151
  v_fma_f32 v10, -v213, v151, v10
  v_cvt_pk_f16_f32 v225, v9, v10
  v_mul_f32 v9, v214, v152
  v_mul_f32 v10, v218, v152
  v_fmac_f32 v9, v218, v153
  v_fma_f32 v10, -v214, v153, v10
  v_cvt_pk_f16_f32 v226, v9, v10
  v_mul_f32 v9, v215, v154
  v_mul_f32 v10, v219, v154
  v_fmac_f32 v9, v219, v155
  v_fma_f32 v10, -v215, v155, v10
  v_cvt_pk_f16_f32 v227, v9, v10
  s_nop 1
  v_mfma_f32_16x16x32_f16 v[228:231], v[160:163], v[224:227], v[228:231]
  v_mfma_f32_16x16x32_f16 v[232:235], v[168:171], v[224:227], v[232:235]
  s_add_u32 s36, s41, 0x430000
  s_waitcnt vmcnt(0)
  s_nop 5
  v_cvt_pk_f16_f32 v172, v228, v232
  v_cvt_pk_f16_f32 v173, v229, v233
  v_cvt_pk_f16_f32 v174, v230, v234
  v_cvt_pk_f16_f32 v175, v231, v235
  buffer_store_dwordx4 v[172:175], v20, s[4:7], s36 offen sc0 sc1
  s_branch M_cy10
  M_cx10:
  s_sleep 8
  s_waitcnt vmcnt(0)
  M_cy10:
  v_mul_u32_u24 v222, 16, v0
  s_and_b32 s36, s2, 3
  s_mul_i32 s36, s36, 4224
  s_add_u32 s36, s36, 0x800000
  s_add_u32 s38, s36, 4096
  v_bitop3_b32 v9, v32, v36, s40 bitop3:0x7e
  v_cmp_ne_u32 vcc, 0, v9
  s_cbranch_vccz M_pz1
  buffer_load_dwordx2 v[36:37], off, s[4:7], s38 sc0 sc1
  s_mov_b32 s37, 0x10000
  s_branch M_pk1
M_pk1s:
  s_sleep 1
M_pk1:
  buffer_load_dwordx3 v[32:34], v222, s[4:7], s36 offen sc0 sc1
  s_sub_u32 s37, s37, 1
  s_waitcnt vmcnt(0)
  v_cmp_ne_u32 vcc, s40, v32
  s_cbranch_scc1 M_pk1x
  s_mov_b64 exec, vcc
  s_cbranch_vccnz M_pk1s
M_pk1x:
  s_mov_b64 exec, -1
  s_mov_b32 s37, 0x10000
  s_branch M_px1c
M_px1s:
  s_sleep 1
M_px1:
  buffer_load_dwordx2 v[36:37], off, s[4:7], s38 sc0 sc1
M_px1c:
  s_sub_u32 s37, s37, 1
  s_waitcnt vmcnt(0)
  v_cmp_ne_u32 vcc, s40, v36
  s_cbranch_scc1 M_px1x
  s_mov_b64 exec, vcc
  s_cbranch_vccnz M_px1s
M_px1x:
  s_mov_b64 exec, -1
M_pz1:
  v_lshrrev_b32 v9, 1, v11
  v_mov_b32 v32, v34
  ds_write_b64 v9, v[32:33] offset:21760
  s_waitcnt lgkmcnt(0)
  s_barrier
  v_lshlrev_b32 v9, 4, v1
  ds_read_b128 v[180:183], v9 offset:21760
  ds_read_b128 v[184:187], v9 offset:22784
  s_waitcnt lgkmcnt(0)
  v_mov_b32 v212, v181
  v_mov_b32 v213, v180
  v_max_u32 v213, v213, v182
  v_med3_u32 v213, v212, v213, v183
  v_max_u32 v212, v212, v183
  v_max_u32 v213, v213, v184
  v_med3_u32 v213, v212, v213, v185
  v_max_u32 v212, v212, v185
  v_max_u32 v213, v213, v186
  v_med3_u32 v213, v212, v213, v187
  v_max_u32 v212, v212, v187
  s_nop 1
  v_mov_b32_dpp v214, v212 quad_perm:[1,0,3,2] row_mask:0xf bank_mask:0xf
  v_mov_b32_dpp v215, v213 quad_perm:[1,0,3,2] row_mask:0xf bank_mask:0xf
  v_max_u32 v213, v213, v215
  v_med3_u32 v213, v212, v213, v214
  v_max_u32 v212, v212, v214
  s_nop 1
  v_mov_b32_dpp v214, v212 quad_perm:[2,3,0,1] row_mask:0xf bank_mask:0xf
  v_mov_b32_dpp v215, v213 quad_perm:[2,3,0,1] row_mask:0xf bank_mask:0xf
  v_max_u32 v213, v213, v215
  v_med3_u32 v213, v212, v213, v214
  v_max_u32 v212, v212, v214
  s_nop 1
  v_mov_b32_dpp v214, v212 row_half_mirror row_mask:0xf bank_mask:0xf
  v_mov_b32_dpp v215, v213 row_half_mirror row_mask:0xf bank_mask:0xf
  v_max_u32 v213, v213, v215
  v_med3_u32 v213, v212, v213, v214
  v_max_u32 v212, v212, v214
  s_nop 1
  v_mov_b32_dpp v214, v212 row_mirror row_mask:0xf bank_mask:0xf
  v_mov_b32_dpp v215, v213 row_mirror row_mask:0xf bank_mask:0xf
  v_max_u32 v213, v213, v215
  v_med3_u32 v213, v212, v213, v214
  v_max_u32 v212, v212, v214
  v_mov_b32 v214, v212
  v_mov_b32 v215, v213
  s_nop 0
  v_permlane16_swap_b32 v212, v214
  v_permlane16_swap_b32 v213, v215
  v_max_u32 v213, v213, v215
  v_med3_u32 v213, v212, v213, v214
  v_max_u32 v212, v212, v214
  v_mov_b32 v214, v212
  v_mov_b32 v215, v213
  s_nop 0
  v_permlane32_swap_b32 v212, v214
  v_permlane32_swap_b32 v213, v215
  v_max_u32 v213, v213, v215
  v_med3_u32 v213, v212, v213, v214
  v_max_u32 v212, v212, v214
  v_med3_u32 v213, v212, v213, v37
  v_max_u32 v212, v212, v37
  s_mov_b32 s36, 8448
  v_readfirstlane_b32 s56, v212
  v_readfirstlane_b32 s57, v213
  v_lshlrev_b32 v220, 7, v3
  v_lshl_add_u32 v220, v2, 1, v220
  v_sub_u32 v221, 928, v220
  v_cmp_eq_u32 vcc, 0, v1
  v_mov_b32 v214, 512
  v_add_u32 v215, 96, v221
  v_cndmask_b32 v214, v220, v214, vcc
  v_and_b32 v215, 1023, v215
  v_lshrrev_b32 v222, 3, v0
  v_lshlrev_b32 v222, 7, v222
  v_and_b32 v9, 3, v0
  v_lshl_add_u32 v222, v9, 5, v222
  v_and_b32 v9, 4, v0
  v_add3_u32 v222, v222, v9, s36
  s_and_b32 s42, s56, 0x73f
  s_and_b32 s43, s57, 0x73f
  s_cmp_eq_u32 s42, s43
  s_cselect_b32 s36, 64, 0
  s_add_u32 s43, s43, s36
  s_mul_i32 s42, s42, 1152
  s_mul_i32 s43, s43, 1152
  s_add_u32 s42, s42, 0x540000
  s_add_u32 s43, s43, 0x540000
  s_and_b32 s36, s56, 2047
  s_sub_u32 s37, 2048, s36
  s_bitcmp1_b32 s56, 11
  s_cselect_b32 s56, s37, s36
  s_and_b32 s36, s57, 2047
  s_sub_u32 s37, 2048, s36
  s_bitcmp1_b32 s57, 11
  s_cselect_b32 s57, s37, s36
  s_cmp_ge_u32 s22, 2
  s_cselect_b32 s36, s43, s42
  v_lshrrev_b32 v212, 1, v11
  v_and_b32 v213, 1023, v212
  s_mov_b32 s37, 0x10000
  s_branch M_go
M_gos:
  s_sleep 1
M_go:
  buffer_load_dwordx4 v[196:199], off, s[4:7], s42 offset:1024 sc0 sc1
  buffer_load_dwordx4 v[200:203], off, s[4:7], s43 offset:1024 sc0 sc1
  buffer_load_dwordx2 v[204:205], v213, s[4:7], s36 offen sc0 sc1
  s_sub_u32 s37, s37, 1
  s_waitcnt vmcnt(0)
  v_max3_u32 v9, v196, v200, v204
  v_cmp_eq_u32 vcc, -1, v9
  s_cbranch_scc1 M_gox
  s_mov_b64 exec, vcc
  s_cbranch_vccnz M_gos
M_gox:
  s_mov_b64 exec, -1
  ds_write_b64 v212, v[204:205] offset:32000
  v_mov_b32 v180, 0
  v_mov_b32 v181, 0
  v_mov_b32 v182, 0
  v_mov_b32 v183, 0
  v_mov_b32 v184, 0
  v_mov_b32 v185, 0
  v_mov_b32 v186, 0
  v_mov_b32 v187, 0
  v_mov_b32 v188, 0
  v_mov_b32 v189, 0
  v_mov_b32 v190, 0
  v_mov_b32 v191, 0
  v_mov_b32 v192, 0
  v_mov_b32 v193, 0
  v_mov_b32 v194, 0
  v_mov_b32 v195, 0
  s_waitcnt lgkmcnt(0)
  s_barrier
  ds_read_u16_d16_hi v180, v214 offset:32000
  ds_read_u16_d16_hi v181, v220 offset:32032
  ds_read_u16_d16_hi v182, v220 offset:32064
  ds_read_u16_d16_hi v183, v220 offset:32096
  ds_read_u16_d16_hi v184, v215 offset:32000
  ds_read_u16_d16_hi v185, v221 offset:32064
  ds_read_u16_d16_hi v186, v221 offset:32032
  ds_read_u16_d16_hi v187, v221 offset:32000
  ds_read_u16_d16_hi v188, v214 offset:33024
  ds_read_u16_d16_hi v189, v220 offset:33056
  ds_read_u16_d16_hi v190, v220 offset:33088
  ds_read_u16_d16_hi v191, v220 offset:33120
  ds_read_u16_d16_hi v192, v215 offset:33024
  ds_read_u16_d16_hi v193, v221 offset:33088
  ds_read_u16_d16_hi v194, v221 offset:33056
  ds_read_u16_d16_hi v195, v221 offset:33024
  s_mul_i32 s36, s56, s23
  s_mul_i32 s37, s57, s23
  s_and_b32 s36, s36, 2047
  s_and_b32 s37, s37, 2047
  v_cvt_f32_u32 v216, s36
  v_cvt_f32_u32 v218, s37
  v_mul_f32 v216, 0x3a000000, v216
  v_mul_f32 v218, 0x3a000000, v218
  v_sin_f32 v217, v216
  v_sin_f32 v219, v218
  v_cos_f32 v216, v216
  v_cos_f32 v218, v218
  v_mul_f32 v216, 0x3e800000, v216
  v_mul_f32 v217, 0x3e800000, v217
  v_mul_f32 v218, 0x3e800000, v218
  v_mul_f32 v219, 0x3e800000, v219
  s_waitcnt lgkmcnt(0)
  v_sub_f32 v224, v180, v196
  v_mul_f32 v224, v224, v199
  v_sub_f32 v225, v181, v196
  v_mul_f32 v225, v225, v199
  v_sub_f32 v226, v182, v196
  v_mul_f32 v226, v226, v199
  v_sub_f32 v227, v183, v196
  v_mul_f32 v227, v227, v199
  v_sub_f32 v228, v184, v196
  v_mul_f32 v228, v228, v199
  v_sub_f32 v229, v185, v196
  v_mul_f32 v229, v229, v199
  v_sub_f32 v230, v186, v196
  v_mul_f32 v230, v230, v199
  v_sub_f32 v231, v187, v196
  v_mul_f32 v231, v231, v199
  v_sub_f32 v232, v188, v200
  v_mul_f32 v232, v232, v203
  v_sub_f32 v233, v189, v200
  v_mul_f32 v233, v233, v203
  v_sub_f32 v234, v190, v200
  v_mul_f32 v234, v234, v203
  v_sub_f32 v235, v191, v200
  v_mul_f32 v235, v235, v203
  v_sub_f32 v236, v192, v200
  v_mul_f32 v236, v236, v203
  v_sub_f32 v237, v193, v200
  v_mul_f32 v237, v237, v203
  v_sub_f32 v238, v194, v200
  v_mul_f32 v238, v238, v203
  v_sub_f32 v239, v195, v200
  v_mul_f32 v239, v239, v203
  v_lshlrev_b32 v220, 2, v220
  v_lshlrev_b32 v221, 2, v221
  v_lshlrev_b32 v214, 2, v214
  v_lshlrev_b32 v215, 2, v215
  s_branch M_al3
  ST10:
  s_branch ST3
  .p2align 12
  ST3:
  s_branch F_back
  M_al3:
  s_and_b32 s39, s2, 15
  s_mul_i32 s39, s39, 4352
  s_add_u32 s39, s39, 0xa80000
  s_add_u32 s38, s25, 0x430000
  s_mov_b32 s37, 0x10000
M_gub:
  buffer_load_dwordx4 v[172:175], v8, s[4:7], s38 offen sc0 sc1
  s_sub_u32 s37, s37, 1
  s_waitcnt vmcnt(0)
  v_and_b32 v175, s21, v175
  v_max_u32 v9, v172, v173
  v_max3_u32 v9, v9, v174, v175
  v_cmp_eq_u32 vcc, -1, v9
  s_cbranch_scc1 M_gubx
  s_mov_b64 exec, vcc
  s_cbranch_vccnz M_gub
M_gubx:
  s_mov_b64 exec, -1
  ds_write_b128 v11, v[172:175] offset:0
  s_mov_b32 s37, 64
  M_wu:
  s_memrealtime s[98:99]
  s_sub_u32 s37, s37, 1
  s_cbranch_scc1 M_wux
  s_waitcnt lgkmcnt(0)
  s_sub_u32 s98, s98, s96
  s_cmp_ge_u32 s98, 430
  s_cbranch_scc1 M_wux
  s_sleep 2
  s_branch M_wu
  M_wux:
  s_mov_b32 s37, 0x10000
M_gup:
  buffer_load_dwordx4 v[240:243], v11, s[4:7], s39 offen sc0 sc1
  s_sub_u32 s37, s37, 1
  s_waitcnt vmcnt(0)
  v_max_u32 v9, v240, v241
  v_max3_u32 v9, v9, v242, v243
  v_cmp_eq_u32 vcc, -1, v9
  s_cbranch_scc1 M_gupx
  s_mov_b64 exec, vcc
  s_cbranch_vccnz M_gup
M_gupx:
  s_mov_b64 exec, -1
  ds_write2_b32 v222, v240, v241 offset0:0 offset1:2
  ds_write2_b32 v222, v242, v243 offset0:4 offset1:6
  s_waitcnt lgkmcnt(0)
  s_barrier
  ds_read_b64 v[196:197], v214 offset:8448
  ds_read_b64 v[198:199], v220 offset:8576
  ds_read_b64 v[200:201], v220 offset:8704
  ds_read_b64 v[202:203], v220 offset:8832
  ds_read_b64 v[204:205], v215 offset:8448
  ds_read_b64 v[206:207], v221 offset:8704
  ds_read_b64 v[208:209], v221 offset:8576
  ds_read_b64 v[210:211], v221 offset:8448
  ds_read2_b32 v[172:173], v15 offset0:0 offset1:32
  ds_read2_b32 v[176:177], v16 offset0:0 offset1:32
  ds_read2_b32 v[174:175], v15 offset0:64 offset1:96
  ds_read2_b32 v[178:179], v16 offset0:64 offset1:96
  s_waitcnt lgkmcnt(0)
  v_pk_fma_f16 v172, v176, v17, v172
  v_pk_fma_f16 v173, v177, v17, v173
  v_pk_fma_f16 v174, v178, v17, v174
  v_pk_fma_f16 v175, v179, v17, v175
  v_add_f32 v180, v180, v196
  v_add_f32 v188, v188, v197
  v_add_f32 v181, v181, v198
  v_add_f32 v189, v189, v199
  v_add_f32 v182, v182, v200
  v_add_f32 v190, v190, v201
  v_add_f32 v183, v183, v202
  v_add_f32 v191, v191, v203
  v_add_f32 v184, v184, v204
  v_add_f32 v192, v192, v205
  v_add_f32 v185, v185, v206
  v_add_f32 v193, v193, v207
  v_add_f32 v186, v186, v208
  v_add_f32 v194, v194, v209
  v_add_f32 v187, v187, v210
  v_add_f32 v195, v195, v211
  v_add_f32 v212, v180, v181
  v_mul_f32 v213, v180, v180
  v_fmac_f32 v213, v181, v181
  v_add_f32 v212, v212, v182
  v_fmac_f32 v213, v182, v182
  v_add_f32 v212, v212, v183
  v_fmac_f32 v213, v183, v183
  v_add_f32 v212, v212, v184
  v_fmac_f32 v213, v184, v184
  v_add_f32 v212, v212, v185
  v_fmac_f32 v213, v185, v185
  v_add_f32 v212, v212, v186
  v_fmac_f32 v213, v186, v186
  v_add_f32 v212, v212, v187
  v_fmac_f32 v213, v187, v187
  v_add_f32 v214, v188, v189
  v_mul_f32 v215, v188, v188
  v_fmac_f32 v215, v189, v189
  v_add_f32 v214, v214, v190
  v_fmac_f32 v215, v190, v190
  v_add_f32 v214, v214, v191
  v_fmac_f32 v215, v191, v191
  v_add_f32 v214, v214, v192
  v_fmac_f32 v215, v192, v192
  v_add_f32 v214, v214, v193
  v_fmac_f32 v215, v193, v193
  v_add_f32 v214, v214, v194
  v_fmac_f32 v215, v194, v194
  v_add_f32 v214, v214, v195
  v_fmac_f32 v215, v195, v195
  s_nop 0
  v_permlane32_swap_b32 v212, v214
  v_add_f32 v212, v212, v214
  v_permlane32_swap_b32 v213, v215
  v_add_f32 v213, v213, v215
  v_add_f32_dpp v212, v212, v212 quad_perm:[1,0,3,2] row_mask:0xf bank_mask:0xf
  s_nop 0
  v_add_f32_dpp v213, v213, v213 quad_perm:[1,0,3,2] row_mask:0xf bank_mask:0xf
  v_add_f32_dpp v212, v212, v212 quad_perm:[2,3,0,1] row_mask:0xf bank_mask:0xf
  s_nop 0
  v_add_f32_dpp v213, v213, v213 quad_perm:[2,3,0,1] row_mask:0xf bank_mask:0xf
  v_add_f32_dpp v212, v212, v212 row_half_mirror row_mask:0xf bank_mask:0xf
  s_nop 0
  v_add_f32_dpp v213, v213, v213 row_half_mirror row_mask:0xf bank_mask:0xf
  v_add_f32_dpp v212, v212, v212 row_mirror row_mask:0xf bank_mask:0xf
  s_nop 0
  v_add_f32_dpp v213, v213, v213 row_mirror row_mask:0xf bank_mask:0xf
  v_add_f32_dpp v212, v212, v212 row_bcast:15 row_mask:0xa bank_mask:0xf
  s_nop 0
  v_add_f32_dpp v213, v213, v213 row_bcast:15 row_mask:0xa bank_mask:0xf
  v_mul_f32 v212, 0x3b000000, v212
  v_mul_f32 v213, 0x3b000000, v213
  v_fma_f32 v213, -v212, v212, v213
  v_max_f32 v213, 0, v213
  v_add_f32 v213, 0x3727c5ac, v213
  v_rsq_f32 v213, v213
  v_cmp_eq_u32 vcc, 0, v1
  v_mul_f32 v212, v212, v213
  v_readlane_b32 s48, v213, 16
  v_readlane_b32 s49, v213, 48
  v_readlane_b32 s50, v212, 16
  v_readlane_b32 s51, v212, 48
  v_fma_f32 v180, v180, s48, -v224
  v_fma_f32 v181, v181, s48, -v225
  v_fma_f32 v182, v182, s48, -v226
  v_fma_f32 v183, v183, s48, -v227
  v_fma_f32 v184, v184, s48, -v228
  v_fma_f32 v185, v185, s48, -v229
  v_fma_f32 v186, v186, s48, -v230
  v_fma_f32 v187, v187, s48, -v231
  v_cndmask_b32 v184, v184, v180, vcc
  v_mov_b32 v9, s50
  v_add_f32 v224, v180, v184
  v_sub_f32 v228, v180, v184
  v_fma_f32 v224, v9, -2.0, v224
  v_add_f32 v225, v181, v185
  v_sub_f32 v229, v181, v185
  v_fma_f32 v225, v9, -2.0, v225
  v_add_f32 v226, v182, v186
  v_sub_f32 v230, v182, v186
  v_fma_f32 v226, v9, -2.0, v226
  v_add_f32 v227, v183, v187
  v_sub_f32 v231, v183, v187
  v_fma_f32 v227, v9, -2.0, v227
  v_fma_f32 v188, v188, s49, -v232
  v_fma_f32 v189, v189, s49, -v233
  v_fma_f32 v190, v190, s49, -v234
  v_fma_f32 v191, v191, s49, -v235
  v_fma_f32 v192, v192, s49, -v236
  v_fma_f32 v193, v193, s49, -v237
  v_fma_f32 v194, v194, s49, -v238
  v_fma_f32 v195, v195, s49, -v239
  v_cndmask_b32 v192, v192, v188, vcc
  v_mov_b32 v9, s51
  v_add_f32 v232, v188, v192
  v_sub_f32 v236, v188, v192
  v_fma_f32 v232, v9, -2.0, v232
  v_add_f32 v233, v189, v193
  v_sub_f32 v237, v189, v193
  v_fma_f32 v233, v9, -2.0, v233
  v_add_f32 v234, v190, v194
  v_sub_f32 v238, v190, v194
  v_fma_f32 v234, v9, -2.0, v234
  v_add_f32 v235, v191, v195
  v_sub_f32 v239, v191, v195
  v_fma_f32 v235, v9, -2.0, v235
  v_mul_f32 v224, v224, v216
  v_mul_f32 v228, v228, v217
  v_fmac_f32 v224, v232, v218
  v_fmac_f32 v228, v236, v219
  v_cndmask_b32 v9, v224, v228, s[46:47]
  v_cndmask_b32 v10, -v228, v224, s[46:47]
  v_cvt_pk_f16_f32 v9, v9, v10
  v_pk_add_f16 v172, v172, v9
  v_mul_f32 v225, v225, v216
  v_mul_f32 v229, v229, v217
  v_fmac_f32 v225, v233, v218
  v_fmac_f32 v229, v237, v219
  v_cndmask_b32 v9, v225, v229, s[46:47]
  v_cndmask_b32 v10, -v229, v225, s[46:47]
  v_cvt_pk_f16_f32 v9, v9, v10
  v_pk_add_f16 v173, v173, v9
  v_mul_f32 v226, v226, v216
  v_mul_f32 v230, v230, v217
  v_fmac_f32 v226, v234, v218
  v_fmac_f32 v230, v238, v219
  v_cndmask_b32 v9, v226, v230, s[46:47]
  v_cndmask_b32 v10, -v230, v226, s[46:47]
  v_cvt_pk_f16_f32 v9, v9, v10
  v_pk_add_f16 v174, v174, v9
  v_mul_f32 v227, v227, v216
  v_mul_f32 v231, v231, v217
  v_fmac_f32 v227, v235, v218
  v_fmac_f32 v231, v239, v219
  v_cndmask_b32 v9, v227, v231, s[46:47]
  v_cndmask_b32 v10, -v231, v227, s[46:47]
  v_cvt_pk_f16_f32 v9, v9, v10
  v_pk_add_f16 v175, v175, v9
  s_cmp_eq_u32 s56, s23
  s_cselect_b32 s36, 1, 0
  s_cmp_eq_u32 s56, s24
  s_cselect_b32 s37, 1, 0
  s_cmp_eq_u32 s57, s23
  s_cselect_b32 s38, 1, 0
  s_cmp_eq_u32 s57, s24
  s_cselect_b32 s39, 1, 0
  s_or_b32 s48, s36, s37
  s_or_b32 s49, s38, s39
  s_or_b32 s48, s48, s49
  s_cbranch_scc0 M_noown
  v_lshlrev_b32 v212, 2, v5
  v_sub_u32 v213, 4040, v212
  v_lshlrev_b32 v214, 2, v7
  v_cvt_f32_u32 v216, s36
  v_cvt_f32_u32 v217, s37
  v_cvt_f32_u32 v218, s38
  v_cvt_f32_u32 v219, s39
  ds_read_b128 v[180:183], v212 offset:8448
  ds_read_b128 v[184:187], v212 offset:8464
  ds_read_b128 v[188:191], v212 offset:8480
  ds_read_b128 v[192:195], v212 offset:8496
  ds_read_b64 v[196:197], v214 offset:8448
  ds_read_b64 v[198:199], v213 offset:8496
  ds_read_b64 v[200:201], v213 offset:8488
  ds_read_b64 v[202:203], v213 offset:8480
  ds_read_b64 v[204:205], v213 offset:8472
  ds_read_b64 v[206:207], v213 offset:8464
  ds_read_b64 v[208:209], v213 offset:8456
  ds_read_b64 v[210:211], v213 offset:8448
  s_waitcnt lgkmcnt(0)
  v_fmac_f32 v38, v180, v216
  v_fmac_f32 v38, v181, v218
  v_fmac_f32 v46, v196, v217
  v_fmac_f32 v46, v197, v219
  v_fmac_f32 v39, v182, v216
  v_fmac_f32 v39, v183, v218
  v_fmac_f32 v47, v198, v217
  v_fmac_f32 v47, v199, v219
  v_fmac_f32 v40, v184, v216
  v_fmac_f32 v40, v185, v218
  v_fmac_f32 v48, v200, v217
  v_fmac_f32 v48, v201, v219
  v_fmac_f32 v41, v186, v216
  v_fmac_f32 v41, v187, v218
  v_fmac_f32 v49, v202, v217
  v_fmac_f32 v49, v203, v219
  v_fmac_f32 v42, v188, v216
  v_fmac_f32 v42, v189, v218
  v_fmac_f32 v50, v204, v217
  v_fmac_f32 v50, v205, v219
  v_fmac_f32 v43, v190, v216
  v_fmac_f32 v43, v191, v218
  v_fmac_f32 v51, v206, v217
  v_fmac_f32 v51, v207, v219
  v_fmac_f32 v44, v192, v216
  v_fmac_f32 v44, v193, v218
  v_fmac_f32 v52, v208, v217
  v_fmac_f32 v52, v209, v219
  v_fmac_f32 v45, v194, v216
  v_fmac_f32 v45, v195, v218
  v_fmac_f32 v53, v210, v217
  v_fmac_f32 v53, v211, v219
M_noown:
  s_cmp_lg_u32 s60, 0
  s_cbranch_scc1 M_nokey5
  v_mfma_f32_16x16x32_f16 v[180:183], v[172:175], v[72:75], 0
  v_mfma_f32_16x16x32_f16 v[184:187], v[172:175], v[76:79], 0
  v_mfma_f32_16x16x32_f16 v[188:191], v[172:175], v[80:83], 0
  v_mfma_f32_16x16x32_f16 v[192:195], v[172:175], v[84:87], 0
  v_cvt_f32_f16 v10, v172
  s_mov_b32 s54, 0x41800000
  v_readlane_b32 s52, v10, 0
  s_nop 1
  v_mul_f32 v9, v180, v88
  v_mul_f32 v10, v184, v88
  v_fmac_f32 v9, v184, v89
  v_fma_f32 v10, -v180, v89, v10
  v_cvt_pk_f16_f32 v196, v9, v10
  v_mul_f32 v9, v181, v90
  v_mul_f32 v10, v185, v90
  v_fmac_f32 v9, v185, v91
  v_fma_f32 v10, -v181, v91, v10
  v_cvt_pk_f16_f32 v197, v9, v10
  v_mul_f32 v9, v182, v92
  v_mul_f32 v10, v186, v92
  v_fmac_f32 v9, v186, v93
  v_fma_f32 v10, -v182, v93, v10
  v_cvt_pk_f16_f32 v198, v9, v10
  v_mul_f32 v9, v183, v94
  v_mul_f32 v10, v187, v94
  v_fmac_f32 v9, v187, v95
  v_fma_f32 v10, -v183, v95, v10
  v_cvt_pk_f16_f32 v199, v9, v10
  s_nop 1
  v_mfma_f32_16x16x32_f16 v[204:207], v[196:199], v[104:107], 0
  v_mul_f32 v9, v188, v96
  v_mul_f32 v10, v192, v96
  v_fmac_f32 v9, v192, v97
  v_fma_f32 v10, -v188, v97, v10
  v_cvt_pk_f16_f32 v200, v9, v10
  v_mul_f32 v9, v189, v98
  v_mul_f32 v10, v193, v98
  v_fmac_f32 v9, v193, v99
  v_fma_f32 v10, -v189, v99, v10
  v_cvt_pk_f16_f32 v201, v9, v10
  v_mul_f32 v9, v190, v100
  v_mul_f32 v10, v194, v100
  v_fmac_f32 v9, v194, v101
  v_fma_f32 v10, -v190, v101, v10
  v_cvt_pk_f16_f32 v202, v9, v10
  v_mul_f32 v9, v191, v102
  v_mul_f32 v10, v195, v102
  v_fmac_f32 v9, v195, v103
  v_fma_f32 v10, -v191, v103, v10
  v_cvt_pk_f16_f32 v203, v9, v10
  s_nop 1
  v_mfma_f32_16x16x32_f16 v[208:211], v[200:203], v[104:107], 0
  v_readlane_b32 s53, v204, 0
  v_mov_b32 v10, s52
  v_mul_f32 v10, -4.0, v10
  v_mov_b32 v9, s53
  v_mul_f32 v9, 0xc1800000, v9
  v_add_f32 v10, v10, v9
  v_fma_f32 v204, v204, s54, v9
  v_add_f32 v38, v38, v204
  v_add_f32 v46, v46, v204
  v_fma_f32 v205, v205, s54, v10
  v_add_f32 v39, v39, v205
  v_add_f32 v47, v47, v205
  v_fma_f32 v206, v206, s54, v9
  v_add_f32 v40, v40, v206
  v_add_f32 v48, v48, v206
  v_fma_f32 v207, v207, s54, v10
  v_add_f32 v41, v41, v207
  v_add_f32 v49, v49, v207
  v_fma_f32 v208, v208, s54, v9
  v_add_f32 v42, v42, v208
  v_add_f32 v50, v50, v208
  v_fma_f32 v209, v209, s54, v10
  v_add_f32 v43, v43, v209
  v_add_f32 v51, v51, v209
  v_fma_f32 v210, v210, s54, v9
  v_add_f32 v44, v44, v210
  v_add_f32 v52, v52, v210
  v_fma_f32 v211, v211, s54, v10
  v_add_f32 v45, v45, v211
  v_add_f32 v53, v53, v211
  v_add_f32 v196, v38, v39
  v_mul_f32 v197, v38, v38
  v_mul_f32 v200, v38, v54
  v_fmac_f32 v197, v39, v39
  v_fmac_f32 v200, v39, v55
  v_add_f32 v196, v196, v40
  v_fmac_f32 v197, v40, v40
  v_fmac_f32 v200, v40, v56
  v_add_f32 v196, v196, v41
  v_fmac_f32 v197, v41, v41
  v_fmac_f32 v200, v41, v57
  v_add_f32 v196, v196, v42
  v_fmac_f32 v197, v42, v42
  v_fmac_f32 v200, v42, v58
  v_add_f32 v196, v196, v43
  v_fmac_f32 v197, v43, v43
  v_fmac_f32 v200, v43, v59
  v_add_f32 v196, v196, v44
  v_fmac_f32 v197, v44, v44
  v_fmac_f32 v200, v44, v60
  v_add_f32 v196, v196, v45
  v_fmac_f32 v197, v45, v45
  v_fmac_f32 v200, v45, v61
  v_add_f32 v198, v46, v47
  v_mul_f32 v199, v46, v46
  v_mul_f32 v201, v46, v62
  v_fmac_f32 v199, v47, v47
  v_fmac_f32 v201, v47, v63
  v_add_f32 v198, v198, v48
  v_fmac_f32 v199, v48, v48
  v_fmac_f32 v201, v48, v64
  v_add_f32 v198, v198, v49
  v_fmac_f32 v199, v49, v49
  v_fmac_f32 v201, v49, v65
  v_add_f32 v198, v198, v50
  v_fmac_f32 v199, v50, v50
  v_fmac_f32 v201, v50, v66
  v_add_f32 v198, v198, v51
  v_fmac_f32 v199, v51, v51
  v_fmac_f32 v201, v51, v67
  v_add_f32 v198, v198, v52
  v_fmac_f32 v199, v52, v52
  v_fmac_f32 v201, v52, v68
  v_add_f32 v198, v198, v53
  v_fmac_f32 v199, v53, v53
  v_fmac_f32 v201, v53, v69
  v_permlane32_swap_b32 v196, v198
  v_add_f32 v196, v196, v198
  v_permlane32_swap_b32 v197, v199
  v_add_f32 v197, v197, v199
  v_permlane32_swap_b32 v200, v201
  v_add_f32 v200, v200, v201
  v_add_f32_dpp v196, v196, v196 quad_perm:[1,0,3,2] row_mask:0xf bank_mask:0xf
  v_add_f32_dpp v197, v197, v197 quad_perm:[1,0,3,2] row_mask:0xf bank_mask:0xf
  v_add_f32_dpp v200, v200, v200 quad_perm:[1,0,3,2] row_mask:0xf bank_mask:0xf
  v_add_f32_dpp v196, v196, v196 quad_perm:[2,3,0,1] row_mask:0xf bank_mask:0xf
  v_add_f32_dpp v197, v197, v197 quad_perm:[2,3,0,1] row_mask:0xf bank_mask:0xf
  v_add_f32_dpp v200, v200, v200 quad_perm:[2,3,0,1] row_mask:0xf bank_mask:0xf
  v_add_f32_dpp v196, v196, v196 row_half_mirror row_mask:0xf bank_mask:0xf
  v_add_f32_dpp v197, v197, v197 row_half_mirror row_mask:0xf bank_mask:0xf
  v_add_f32_dpp v200, v200, v200 row_half_mirror row_mask:0xf bank_mask:0xf
  v_add_f32_dpp v196, v196, v196 row_mirror row_mask:0xf bank_mask:0xf
  v_add_f32_dpp v197, v197, v197 row_mirror row_mask:0xf bank_mask:0xf
  v_add_f32_dpp v200, v200, v200 row_mirror row_mask:0xf bank_mask:0xf
  v_add_f32_dpp v196, v196, v196 row_bcast:15 row_mask:0xa bank_mask:0xf
  v_add_f32_dpp v197, v197, v197 row_bcast:15 row_mask:0xa bank_mask:0xf
  v_add_f32_dpp v200, v200, v200 row_bcast:15 row_mask:0xa bank_mask:0xf
  v_mul_f32 v196, 0x3b000000, v196
  v_mul_f32 v197, 0x3b000000, v197
  v_fma_f32 v197, -v196, v196, v197
  v_max_f32 v197, 0, v197
  v_add_f32 v199, 0x3727c5ac, v197
  v_rsq_f32 v199, v199
  s_nop 0
  v_add_f32 v208, 1.0, v199
  v_fma_f32 v200, -v196, v18, v200
  v_mul_f32 v209, v196, v199
  v_mul_f32 v197, v197, v208
  v_rcp_f32 v205, v208
  v_mul_f32 v197, v197, v208
  v_mul_f32 v206, v200, v199
  v_add_f32 v197, 0x3727c5ac, v197
  v_mov_b32 v204, v196
  v_rsq_f32 v207, v197
  v_mul_f32 v205, v205, v199
  v_readlane_b32 s48, v208, 16
  v_readlane_b32 s49, v208, 48
  v_readlane_b32 s50, v209, 16
  v_readlane_b32 s51, v209, 48
  v_mul_f32 v210, v207, v208
  v_and_b32 v9, 32, v0
  v_ashrrev_i32 v208, 31, v206
  v_lshl_add_u32 v9, v9, 6, s23
  v_or_b32 v208, 0x80000000, v208
  v_lshrrev_b32 v10, 3, v0
  v_xor_b32 v208, v208, v206
  v_and_b32 v10, 60, v10
  v_and_b32 v208, 0xfffff000, v208
  s_cmp_eq_u32 s23, s24
  s_cselect_b32 s36, 0, 0x10000
  v_or_b32 v208, v208, v9
  s_cmp_lg_u32 s60, 0
  s_cbranch_scc1 M_nokey5
  s_mov_b32 exec_lo, 0x10000
  s_mov_b32 exec_hi, s36
  ds_write_b32 v10, v208 offset:8192
  s_mov_b64 exec, -1
  M_nokey5:
  v_lshlrev_b32 v9, 2, v2
  v_mov_b32 v34, 0
  v_mov_b32 v32, s40
  s_lshl_b32 s38, s2, 7
  s_add_u32 s38, s38, 0x790000
  s_and_b32 s39, s2, 7
  s_lshl_b32 s39, s39, 5
  s_bfe_u32 s37, s2, 0x50003
  s_add_u32 s39, s39, s37
  s_and_b32 s37, s2, 256
  s_add_u32 s39, s39, s37
  s_mul_i32 s39, s39, 16
  s_add_u32 s39, s39, 0x940000
  s_mul_i32 s37, s22, 135168
  s_add_u32 s39, s39, s37
  v_lshrrev_b32 v239, 1, v1
  v_and_b32 v239, 24, v239
  v_and_or_b32 v239, v1, 7, v239
  v_mul_u32_u24 v239, 4224, v239
  s_waitcnt lgkmcnt(0)
  s_barrier
  ds_read_b32 v33, v9 offset:8192
  s_waitcnt lgkmcnt(0)
  v_mov_b32_dpp v237, v33 quad_perm:[1,0,3,2] row_mask:0xf bank_mask:0xf
  v_mov_b32_dpp v238, v34 quad_perm:[1,0,3,2] row_mask:0xf bank_mask:0xf
  v_max_u32 v34, v34, v238
  v_med3_u32 v34, v33, v34, v237
  v_max_u32 v33, v33, v237
  s_nop 1
  v_mov_b32_dpp v237, v33 quad_perm:[2,3,0,1] row_mask:0xf bank_mask:0xf
  v_mov_b32_dpp v238, v34 quad_perm:[2,3,0,1] row_mask:0xf bank_mask:0xf
  v_max_u32 v34, v34, v238
  v_med3_u32 v34, v33, v34, v237
  v_max_u32 v33, v33, v237
  s_nop 1
  v_mov_b32_dpp v237, v33 row_half_mirror row_mask:0xf bank_mask:0xf
  v_mov_b32_dpp v238, v34 row_half_mirror row_mask:0xf bank_mask:0xf
  v_max_u32 v34, v34, v238
  v_med3_u32 v34, v33, v34, v237
  v_max_u32 v33, v33, v237
  s_cmp_ge_u32 s22, 1
  s_cbranch_scc1 M_nopub5
  s_mov_b64 exec, 15
  buffer_store_dwordx4 v[32:35], v239, s[4:7], s39 offen sc0 sc1
  s_mov_b64 exec, -1
  M_nopub5:
  s_lshr_b32 s36, s2, 3
  s_or_b32 s36, s36, s22
  s_cbranch_scc1 M_hu2
  s_lshl_b32 s36, s2, 7
  s_add_u32 s36, s36, 0x7c0400
  v_mov_b32 v9, s40
  s_mov_b64 exec, 1
  buffer_store_dword v9, off, s[4:7], s36 sc0 sc1
  s_mov_b64 exec, -1
  M_hu2:
  s_cmp_lg_u32 s60, 0
  s_cbranch_scc1 M_cd51
  v_readfirstlane_b32 s52, v33
  v_readfirstlane_b32 s53, v34
  v_mov_b32 v9, s50
  v_mov_b32 v10, s51
  v_fma_f32 v46, v46, s49, -v10
  ds_bpermute_b32 v236, v14, v46
  v_fma_f32 v47, v47, s49, -v10
  v_fma_f32 v48, v48, s49, -v10
  v_fma_f32 v49, v49, s49, -v10
  v_fma_f32 v50, v50, s49, -v10
  v_fma_f32 v51, v51, s49, -v10
  v_fma_f32 v52, v52, s49, -v10
  v_fma_f32 v53, v53, s49, -v10
  v_fma_f32 v38, v38, s48, -v9
  v_fma_f32 v39, v39, s48, -v9
  v_fma_f32 v40, v40, s48, -v9
  v_fma_f32 v41, v41, s48, -v9
  v_fma_f32 v42, v42, s48, -v9
  v_fma_f32 v43, v43, s48, -v9
  v_fma_f32 v44, v44, s48, -v9
  v_fma_f32 v45, v45, s48, -v9
  v_cvt_pk_bf16_f32 v228, v38, v39
  v_cvt_pk_bf16_f32 v229, v40, v41
  v_cvt_pk_bf16_f32 v230, v42, v43
  v_cvt_pk_bf16_f32 v231, v44, v45
  v_cvt_pk_bf16_f32 v233, v52, v51
  v_cvt_pk_bf16_f32 v234, v50, v49
  v_cvt_pk_bf16_f32 v235, v48, v47
  s_lshl_b32 s36, s22, 11
  v_add_u32 v9, s36, v5
  v_add_u32 v10, s36, v6
  ds_write_b128 v9, v[228:231] offset:23808
  v_lshl_add_u32 v9, v1, 4, s36
  s_waitcnt lgkmcnt(1)
  v_cvt_pk_bf16_f32 v232, v236, v53
  ds_write_b128 v10, v[232:235] offset:24832
  v_lshlrev_b32 v236, 4, v1
  ds_read_b128 v[228:231], v9 offset:23808
  ds_read_b128 v[232:235], v9 offset:24832
  s_and_b32 s36, s23, 0x73f
  s_mul_i32 s36, s36, 1152
  s_add_u32 s36, s36, 0x564000
  s_mov_b32 s54, 0
  s_waitcnt lgkmcnt(0)
  s_and_b32 s37, s52, 2047
  s_cmp_lg_u32 s37, s23
  s_cbranch_scc1 M_cd50
  s_bitcmp1_b32 s52, 11
  s_cbranch_scc1 M_cb50
  buffer_store_dwordx4 v[228:231], v236, s[4:7], s36 offen sc0 sc1
  s_mov_b64 exec, 0x10000
  s_bitset1_b32 s54, 0
  s_branch M_cs50
  M_cb50:
  buffer_store_dwordx4 v[232:235], v236, s[4:7], s36 offen sc0 sc1
  s_mov_b32 exec_lo, 0
  s_mov_b32 exec_hi, 0x10000
  s_bitset1_b32 s54, 1
  M_cs50:
  buffer_store_dwordx4 v[204:207], off, s[4:7], s36 offset:1024 sc0 sc1
  s_mov_b64 exec, -1
  M_cd50:
  s_add_u32 s36, s36, 73728
  s_and_b32 s37, s53, 2047
  s_cmp_lg_u32 s37, s23
  s_cbranch_scc1 M_cd51
  s_bitcmp1_b32 s53, 11
  s_cbranch_scc1 M_cb51
  buffer_store_dwordx4 v[228:231], v236, s[4:7], s36 offen sc0 sc1
  s_mov_b64 exec, 0x10000
  s_bitset1_b32 s54, 0
  s_branch M_cs51
  M_cb51:
  buffer_store_dwordx4 v[232:235], v236, s[4:7], s36 offen sc0 sc1
  s_mov_b32 exec_lo, 0
  s_mov_b32 exec_hi, 0x10000
  s_bitset1_b32 s54, 1
  M_cs51:
  buffer_store_dwordx4 v[204:207], off, s[4:7], s36 offset:1024 sc0 sc1
  s_mov_b64 exec, -1
  M_cd51:
  s_cmp_eq_u32 s23, s24
  s_cselect_b32 s55, 1, 3
  s_cmp_lg_u32 s60, 0
  s_cbranch_scc1 M_noout
  s_andn2_b32 s36, s55, s54
  s_and_b32 s55, s55, s54
  s_bitcmp1_b32 s36, 0
  s_cbranch_scc0 M_o00
  buffer_store_dwordx4 v[228:231], v236, s[16:19], s28 offen
  M_o00:
  s_bitcmp1_b32 s36, 1
  s_cbranch_scc0 M_o01
  buffer_store_dwordx4 v[232:235], v236, s[16:19], s29 offen
  M_o01:
  s_bitcmp1_b32 s55, 0
  s_cbranch_scc0 M_o10
  buffer_store_dwordx4 v[228:231], v236, s[16:19], s28 offen sc0 sc1
  M_o10:
  s_bitcmp1_b32 s55, 1
  s_cbranch_scc0 M_o11
  buffer_store_dwordx4 v[232:235], v236, s[16:19], s29 offen sc0 sc1
  M_o11:
M_noout:
WENDB:
  s_or_b32 s36, s2, s22
  s_cbranch_scc1 M_noep
  v_mov_b32 v9, s40
  v_mov_b32 v10, 0
  s_mov_b32 s36, 0x7c1000
  buffer_store_dword v9, v10, s[4:7], s36 offen sc0 sc1
M_noep:
  s_cmp_lg_u32 s22, 0
  s_waitcnt vmcnt(0)
  s_barrier
  s_cbranch_scc1 M_fin
  s_mov_b64 exec, 1
  buffer_store_dword v32, off, s[4:7], s38 offset:64 sc0 sc1
  M_fin:
  s_endpgm
  .p2align 12
L_ffn:
  s_cmp_ge_u32 s3, 248
  s_cbranch_scc1 F_end
  v_and_b32 v1, 63, v0
  v_and_b32 v2, 15, v0
  v_bfe_u32 v3, v0, 4, 2
  v_mul_u32_u24 v9, 16, v0
  s_and_b32 s20, s3, 7
  s_bfe_u32 s21, s3, 0x20003
  v_lshrrev_b32 v4, 1, v1
  v_and_b32 v5, 1, v1
  v_cmp_eq_u32 s[52:53], 1, v5
  v_lshlrev_b32 v5, 4, v5
  v_lshlrev_b32 v7, 8, v3
  v_lshl_add_u32 v7, v2, 3, v7
  v_lshlrev_b32 v8, 4, v1
  v_cmp_gt_u32 s[54:55], 2, v2
  s_lshl_b32 s61, s20, 7
  s_add_u32 s61, s61, 0x7c0000
  s_mov_b32 s27, 0xbfb8aa3b
  s_waitcnt lgkmcnt(0)
  s_add_u32 s38, s30, 0x7c1000
  s_addc_u32 s39, s31, 0
  s_load_dword s40, s[38:39], 0
  s_mov_b32 s4, s30
  s_mov_b32 s5, s31
  s_mov_b32 s6, 0x10000000
  s_mov_b32 s7, 0x20000
  s_mov_b32 s8, s58
  s_mov_b32 s9, s59
  s_mov_b32 s10, 0x200000
  s_mov_b32 s11, 0x20000
F_back:
  s_cmp_ge_u32 s3, 128
  s_cbranch_scc1 F_cons
  s_lshr_b32 s23, s3, 5
  s_lshl_b32 s23, s23, 3
  s_add_u32 s23, s23, s20
  s_cmp_ge_u32 s23, 28
  s_cbranch_scc1 F_end
  s_lshl_b32 s23, s23, 7
  s_lshl_b32 s24, s21, 5
  s_add_u32 s23, s23, s24
  s_mul_i32 s24, s22, 458752
  s_add_u32 s24, s24, s23
  s_mov_b32 s25, 3584
  v_mad_u32_u24 v6, v4, s25, v5
  s_mov_b32 s12, s46
  s_mov_b32 s13, s47
  s_mov_b32 s14, 0x1c0000
  s_mov_b32 s15, 0x20000
  s_mov_b32 s16, s48
  s_mov_b32 s17, s49
  s_mov_b32 s18, 0x1c0000
  s_mov_b32 s19, 0x20000
  v_mul_u32_u24 v10, 3, v5
  v_add_u32 v10, v10, v6
  s_lshl_b32 s36, s21, 2
  s_add_u32 s36, s36, s22
  s_mul_i32 s36, s36, 114688
  s_andn2_b32 s37, s23, 127
  s_add_u32 s36, s36, s37
  buffer_load_dword v88, v10, s[12:15], s36 offen
  s_waitcnt vmcnt(0)
  buffer_load_dword v89, v10, s[16:19], s36 offen
  s_waitcnt vmcnt(0)
  s_mov_b32 s37, 64
  F_wp:
  s_memrealtime s[98:99]
  s_sub_u32 s37, s37, 1
  s_cbranch_scc1 F_wpx
  s_waitcnt lgkmcnt(0)
  s_sub_u32 s98, s98, s96
  s_cmp_ge_u32 s98, 300
  s_cbranch_scc1 F_wpx
  s_sleep 2
  s_branch F_wp
  F_wpx:
  buffer_load_dwordx4 v[88:91], v6, s[12:15], s24 offen
  s_waitcnt vmcnt(1)
  buffer_load_dwordx4 v[104:107], v6, s[16:19], s24 offen
  s_waitcnt vmcnt(1)
  s_add_u32 s24, s24, 114688
  buffer_load_dwordx4 v[92:95], v6, s[12:15], s24 offen
  s_waitcnt vmcnt(1)
  buffer_load_dwordx4 v[108:111], v6, s[16:19], s24 offen
  s_waitcnt vmcnt(1)
  s_add_u32 s24, s24, 114688
  buffer_load_dwordx4 v[96:99], v6, s[12:15], s24 offen
  s_waitcnt vmcnt(1)
  buffer_load_dwordx4 v[112:115], v6, s[16:19], s24 offen
  s_waitcnt vmcnt(1)
  s_add_u32 s24, s24, 114688
  buffer_load_dwordx4 v[100:103], v6, s[12:15], s24 offen
  s_waitcnt vmcnt(1)
  buffer_load_dwordx4 v[116:119], v6, s[16:19], s24 offen
  s_waitcnt vmcnt(1)
  s_lshl_b32 s25, s22, 13
  v_add_u32 v7, s25, v7
  v_add_u32 v8, s25, v8
  s_waitcnt vmcnt(0)
  ds_write_b128 v8, v[88:91] offset:0
  ds_write_b128 v8, v[92:95] offset:1024
  ds_write_b128 v8, v[96:99] offset:2048
  ds_write_b128 v8, v[100:103] offset:3072
  ds_write_b128 v8, v[104:107] offset:4096
  ds_write_b128 v8, v[108:111] offset:5120
  ds_write_b128 v8, v[112:115] offset:6144
  ds_write_b128 v8, v[116:119] offset:7168
  s_waitcnt lgkmcnt(0)
  s_mul_i32 s40, s40, 0x9e3779b1
  s_add_u32 s40, s40, 0x7f4a7c15
  ds_read_b64_tr_b16 v[32:33], v7 offset:0
  ds_read_b64_tr_b16 v[34:35], v7 offset:128
  ds_read_b64_tr_b16 v[36:37], v7 offset:1024
  ds_read_b64_tr_b16 v[38:39], v7 offset:1152
  ds_read_b64_tr_b16 v[40:41], v7 offset:2048
  ds_read_b64_tr_b16 v[42:43], v7 offset:2176
  ds_read_b64_tr_b16 v[44:45], v7 offset:3072
  ds_read_b64_tr_b16 v[46:47], v7 offset:3200
  ds_read_b64_tr_b16 v[48:49], v7 offset:4096
  ds_read_b64_tr_b16 v[50:51], v7 offset:4224
  ds_read_b64_tr_b16 v[52:53], v7 offset:5120
  ds_read_b64_tr_b16 v[54:55], v7 offset:5248
  ds_read_b64_tr_b16 v[56:57], v7 offset:6144
  ds_read_b64_tr_b16 v[58:59], v7 offset:6272
  ds_read_b64_tr_b16 v[60:61], v7 offset:7168
  ds_read_b64_tr_b16 v[62:63], v7 offset:7296
  v_mov_b32 v88, 0x3f803f80
  v_mov_b32 v89, 0x3f803f80
  v_mov_b32 v90, 0x3f803f80
  v_mov_b32 v91, 0x3f803f80
  v_mov_b32 v92, 0x3f803f80
  v_mov_b32 v93, 0x3f803f80
  v_mov_b32 v94, 0x3f803f80
  v_mov_b32 v95, 0x3f803f80
  v_mov_b32 v96, 0x3f803f80
  v_mov_b32 v97, 0x3f803f80
  v_mov_b32 v98, 0x3f803f80
  v_mov_b32 v99, 0x3f803f80
  v_mov_b32 v100, 0x3f803f80
  v_mov_b32 v101, 0x3f803f80
  v_mov_b32 v102, 0x3f803f80
  v_mov_b32 v103, 0x3f803f80
  v_lshlrev_b32 v10, 5, v2
  v_lshl_add_u32 v10, v3, 3, v10
  v_lshlrev_b32 v7, 6, v2
  v_lshl_add_u32 v7, v3, 4, v7
  s_lshl_b32 s26, s22, 8
  v_add_u32 v8, s26, v7
  v_lshl_add_u32 v6, v3, 4, s26
  s_lshr_b32 s23, s23, 5
  s_mul_i32 s24, s23, 2341
  s_lshr_b32 s24, s24, 16
  s_mul_i32 s24, s24, 768
  s_lshl_b32 s23, s23, 7
  s_add_u32 s23, s23, s24
  s_mul_i32 s24, s22, 139264
  s_add_u32 s23, s23, s24
  v_and_b32 v10, 63, v10
  v_lshrrev_b32 v4, 1, v2
  v_mul_u32_u24 v4, 17408, v4
  v_add_u32 v10, v10, v4
  v_and_b32 v7, 127, v7
  v_cmp_gt_u32 s[62:63], 16, v2
  s_waitcnt lgkmcnt(0)
  v_mfma_f32_16x16x32_bf16 v[184:187], v[32:35], v[88:91], 0
  v_mfma_f32_16x16x32_bf16 v[188:191], v[48:51], v[88:91], 0
  v_mfma_f32_16x16x32_bf16 v[184:187], v[36:39], v[88:91], v[184:187]
  v_mfma_f32_16x16x32_bf16 v[188:191], v[52:55], v[88:91], v[188:191]
  v_mfma_f32_16x16x32_bf16 v[184:187], v[40:43], v[88:91], v[184:187]
  v_mfma_f32_16x16x32_bf16 v[188:191], v[56:59], v[88:91], v[188:191]
  v_mfma_f32_16x16x32_bf16 v[184:187], v[44:47], v[88:91], v[184:187]
  v_mfma_f32_16x16x32_bf16 v[188:191], v[60:63], v[88:91], v[188:191]
  s_mov_b32 s37, 0x10000
  s_branch F_p_g1
F_p_g1s:
  s_sleep 2
F_p_g1:
  buffer_load_dword v12, off, s[4:7], s61 offset:0 sc0 sc1
  s_sub_u32 s37, s37, 1
  s_waitcnt vmcnt(0)
  v_cmp_ne_u32 vcc, s40, v12
  s_cbranch_scc1 F_p_g1x
  s_mov_b64 exec, vcc
  s_cbranch_vccnz F_p_g1s
F_p_g1x:
  s_mov_b64 exec, -1
  s_sleep 6
  s_and_b32 s36, s3, 3
  s_mul_i32 s36, s36, 4224
  s_add_u32 s36, s36, 0x800000
  s_add_u32 s38, s36, 4096
  buffer_load_dwordx2 v[16:17], off, s[4:7], s38 sc0 sc1
  s_mov_b32 s37, 0x10000
F_p_pk1:
  buffer_load_dwordx3 v[12:14], v9, s[4:7], s36 offen sc0 sc1
  s_sub_u32 s37, s37, 1
  s_waitcnt vmcnt(0)
  v_cmp_ne_u32 vcc, s40, v12
  s_cbranch_scc1 F_p_pk1x
  s_mov_b64 exec, vcc
  s_cbranch_vccnz F_p_pk1
F_p_pk1x:
  s_mov_b64 exec, -1
  s_mov_b32 s37, 0x10000
  s_branch F_p_px1c
F_p_px1:
  buffer_load_dwordx2 v[16:17], off, s[4:7], s38 sc0 sc1
F_p_px1c:
  s_sub_u32 s37, s37, 1
  s_waitcnt vmcnt(0)
  v_cmp_ne_u32 vcc, s40, v16
  s_cbranch_scc1 F_p_px1x
  s_mov_b64 exec, vcc
  s_cbranch_vccnz F_p_px1
F_p_px1x:
  s_mov_b64 exec, -1
  s_setprio 3
  v_mov_b32 v18, v13
  v_mov_b32 v19, v14
  s_nop 0
  v_mov_b32_dpp v20, v18 quad_perm:[1,0,3,2] row_mask:0xf bank_mask:0xf
  v_mov_b32_dpp v21, v19 quad_perm:[1,0,3,2] row_mask:0xf bank_mask:0xf
  v_max_u32 v19, v19, v21
  v_med3_u32 v19, v18, v19, v20
  v_max_u32 v18, v18, v20
  s_nop 1
  v_mov_b32_dpp v20, v18 quad_perm:[2,3,0,1] row_mask:0xf bank_mask:0xf
  v_mov_b32_dpp v21, v19 quad_perm:[2,3,0,1] row_mask:0xf bank_mask:0xf
  v_max_u32 v19, v19, v21
  v_med3_u32 v19, v18, v19, v20
  v_max_u32 v18, v18, v20
  s_nop 1
  v_mov_b32_dpp v20, v18 row_half_mirror row_mask:0xf bank_mask:0xf
  v_mov_b32_dpp v21, v19 row_half_mirror row_mask:0xf bank_mask:0xf
  v_max_u32 v19, v19, v21
  v_med3_u32 v19, v18, v19, v20
  v_max_u32 v18, v18, v20
  s_nop 1
  v_mov_b32_dpp v20, v18 row_mirror row_mask:0xf bank_mask:0xf
  v_mov_b32_dpp v21, v19 row_mirror row_mask:0xf bank_mask:0xf
  v_max_u32 v19, v19, v21
  v_med3_u32 v19, v18, v19, v20
  v_max_u32 v18, v18, v20
  v_lshrrev_b32 v4, 4, v0
  v_lshlrev_b32 v4, 3, v4
  v_lshlrev_b32 v5, 3, v2
  ds_write_b64 v4, v[18:19] offset:57344
  s_waitcnt lgkmcnt(0)
  s_barrier
  ds_read_b64 v[18:19], v5 offset:57344
  s_waitcnt lgkmcnt(0)
  v_mov_b32_dpp v20, v18 quad_perm:[1,0,3,2] row_mask:0xf bank_mask:0xf
  v_mov_b32_dpp v21, v19 quad_perm:[1,0,3,2] row_mask:0xf bank_mask:0xf
  v_max_u32 v19, v19, v21
  v_med3_u32 v19, v18, v19, v20
  v_max_u32 v18, v18, v20
  s_nop 1
  v_mov_b32_dpp v20, v18 quad_perm:[2,3,0,1] row_mask:0xf bank_mask:0xf
  v_mov_b32_dpp v21, v19 quad_perm:[2,3,0,1] row_mask:0xf bank_mask:0xf
  v_max_u32 v19, v19, v21
  v_med3_u32 v19, v18, v19, v20
  v_max_u32 v18, v18, v20
  s_nop 1
  v_mov_b32_dpp v20, v18 row_half_mirror row_mask:0xf bank_mask:0xf
  v_mov_b32_dpp v21, v19 row_half_mirror row_mask:0xf bank_mask:0xf
  v_max_u32 v19, v19, v21
  v_med3_u32 v19, v18, v19, v20
  v_max_u32 v18, v18, v20
  s_nop 1
  v_mov_b32_dpp v20, v18 row_mirror row_mask:0xf bank_mask:0xf
  v_mov_b32_dpp v21, v19 row_mirror row_mask:0xf bank_mask:0xf
  v_max_u32 v19, v19, v21
  v_med3_u32 v19, v18, v19, v20
  v_max_u32 v18, v18, v20
  v_med3_u32 v19, v18, v19, v17
  v_max_u32 v18, v18, v17
  v_and_b32 v21, 0x73f, v19
  v_and_b32 v20, 0x73f, v18
  v_add_u32 v4, 64, v21
  v_cmp_eq_u32 vcc, v20, v21
  s_mov_b32 s36, 0x540000
  s_nop 0
  v_cndmask_b32 v21, v21, v4, vcc
  v_cndmask_b32 v20, v20, v21, s[52:53]
  v_mul_u32_u24 v11, 1152, v20
  v_add_u32 v5, v11, v6
  s_mov_b64 exec, s[54:55]
  s_mov_b32 s37, 0x10000
F_gr1:
  buffer_load_dwordx4 v[88:91], v5, s[4:7], s36 offen offset:0 sc0 sc1
  buffer_load_dwordx4 v[92:95], v5, s[4:7], s36 offen offset:64 sc0 sc1
  buffer_load_dwordx4 v[96:99], v5, s[4:7], s36 offen offset:128 sc0 sc1
  buffer_load_dwordx4 v[100:103], v5, s[4:7], s36 offen offset:192 sc0 sc1
  buffer_load_dwordx2 v[28:29], v11, s[4:7], s36 offen offset:1024 sc0 sc1
  s_sub_u32 s37, s37, 1
  s_waitcnt vmcnt(0)
  v_max3_u32 v4, v28, v88, v92
  v_max3_u32 v4, v4, v96, v100
  v_cmp_eq_u32 vcc, -1, v4
  s_cbranch_scc1 F_gr1x
  s_mov_b64 exec, vcc
  s_cbranch_vccnz F_gr1
F_gr1x:
  s_mov_b64 exec, -1
  v_mul_f32 v144, -v184, v28
  v_mul_f32 v145, -v185, v28
  v_mul_f32 v146, -v186, v28
  v_mul_f32 v147, -v187, v28
  v_mul_f32 v148, -v188, v28
  v_mul_f32 v149, -v189, v28
  v_mul_f32 v150, -v190, v28
  v_mul_f32 v151, -v191, v28
  v_mfma_f32_16x16x32_bf16 v[144:147], v[32:35], v[88:91], v[144:147]
  s_nop 0
  v_mfma_f32_16x16x32_bf16 v[148:151], v[48:51], v[88:91], v[148:151]
  v_mfma_f32_16x16x32_bf16 v[144:147], v[36:39], v[92:95], v[144:147]
  v_mfma_f32_16x16x32_bf16 v[148:151], v[52:55], v[92:95], v[148:151]
  v_mfma_f32_16x16x32_bf16 v[144:147], v[40:43], v[96:99], v[144:147]
  v_mfma_f32_16x16x32_bf16 v[148:151], v[56:59], v[96:99], v[148:151]
  v_mfma_f32_16x16x32_bf16 v[144:147], v[44:47], v[100:103], v[144:147]
  v_mfma_f32_16x16x32_bf16 v[148:151], v[60:63], v[100:103], v[148:151]
  s_mov_b64 exec, s[54:55]
  s_add_u32 s36, s23, 0xa91000
  s_cmp_ge_u32 s22, 1
  s_nop 3
  ds_write_b128 v8, v[144:147] offset:57472
  ds_write_b128 v8, v[148:151] offset:57600
  s_mov_b64 exec, -1
  v_mov_b32_dpp v20, v29 row_newbcast:0 row_mask:0xf bank_mask:0xf
  v_mov_b32_dpp v21, v29 row_newbcast:1 row_mask:0xf bank_mask:0xf
  s_mov_b64 exec, s[62:63]
  v_cndmask_b32 v21, v20, v21, s[52:53]
  v_mul_f32 v20, s27, v21
  v_mul_f32 v21, v21, v21
  s_waitcnt lgkmcnt(0)
  s_barrier
  s_cbranch_scc1 F_pn1
  ds_read_b128 v[144:147], v7 offset:57472
  ds_read_b128 v[148:151], v7 offset:57600
  ds_read_b128 v[160:163], v7 offset:57728
  ds_read_b128 v[164:167], v7 offset:57856
  ds_read_b128 v[168:171], v7 offset:57984
  ds_read_b128 v[172:175], v7 offset:58112
  ds_read_b128 v[176:179], v7 offset:58240
  ds_read_b128 v[180:183], v7 offset:58368
  s_waitcnt lgkmcnt(4)
  v_add_f32 v144, v144, v160
  v_add_f32 v145, v145, v161
  v_add_f32 v146, v146, v162
  v_add_f32 v147, v147, v163
  v_add_f32 v148, v148, v164
  v_add_f32 v149, v149, v165
  v_add_f32 v150, v150, v166
  v_add_f32 v151, v151, v167
  s_waitcnt lgkmcnt(2)
  v_add_f32 v144, v144, v168
  v_add_f32 v145, v145, v169
  v_add_f32 v146, v146, v170
  v_add_f32 v147, v147, v171
  v_add_f32 v148, v148, v172
  v_add_f32 v149, v149, v173
  v_add_f32 v150, v150, v174
  v_add_f32 v151, v151, v175
  s_waitcnt lgkmcnt(0)
  v_add_f32 v144, v144, v176
  v_add_f32 v145, v145, v177
  v_add_f32 v146, v146, v178
  v_add_f32 v147, v147, v179
  v_add_f32 v148, v148, v180
  v_add_f32 v149, v149, v181
  v_add_f32 v150, v150, v182
  v_add_f32 v151, v151, v183
  v_mul_f32 v152, v20, v144
  v_mul_f32 v153, v20, v145
  v_mul_f32 v154, v20, v146
  v_mul_f32 v155, v20, v147
  v_exp_f32 v152, v152
  v_mul_f32 v144, v144, v148
  v_exp_f32 v153, v153
  v_mul_f32 v145, v145, v149
  v_exp_f32 v154, v154
  v_mul_f32 v146, v146, v150
  v_exp_f32 v155, v155
  v_mul_f32 v147, v147, v151
  v_add_f32 v152, 1.0, v152
  v_add_f32 v153, 1.0, v153
  v_add_f32 v154, 1.0, v154
  v_add_f32 v155, 1.0, v155
  v_rcp_f32 v152, v152
  v_mul_f32 v144, v144, v21
  v_rcp_f32 v153, v153
  v_mul_f32 v145, v145, v21
  v_rcp_f32 v154, v154
  v_mul_f32 v146, v146, v21
  v_rcp_f32 v155, v155
  v_mul_f32 v147, v147, v21
  v_mul_f32 v144, v144, v152
  v_mul_f32 v145, v145, v153
  v_mul_f32 v146, v146, v154
  v_mul_f32 v147, v147, v155
  v_cvt_pk_bf16_f32 v18, v144, v145
  v_cvt_pk_bf16_f32 v19, v146, v147
  buffer_store_dwordx2 v[18:19], v10, s[4:7], s36 offen sc0 sc1
F_pn1:
  s_mov_b64 exec, -1
  s_setprio 0
  s_mov_b32 s37, 0x10000
  s_branch F_p_g2
F_p_g2s:
  s_sleep 2
F_p_g2:
  buffer_load_dword v12, off, s[4:7], s61 offset:1024 sc0 sc1
  s_sub_u32 s37, s37, 1
  s_waitcnt vmcnt(0)
  v_cmp_ne_u32 vcc, s40, v12
  s_cbranch_scc1 F_p_g2x
  s_mov_b64 exec, vcc
  s_cbranch_vccnz F_p_g2s
F_p_g2x:
  s_mov_b64 exec, -1
  s_sleep 6
  s_and_b32 s36, s3, 3
  s_mul_i32 s36, s36, 4224
  s_add_u32 s36, s36, 0x940000
  s_add_u32 s38, s36, 4096
  buffer_load_dwordx2 v[16:17], off, s[4:7], s38 sc0 sc1
  s_mov_b32 s37, 0x10000
F_p_pk2:
  buffer_load_dwordx3 v[12:14], v9, s[4:7], s36 offen sc0 sc1
  s_sub_u32 s37, s37, 1
  s_waitcnt vmcnt(0)
  v_cmp_ne_u32 vcc, s40, v12
  s_cbranch_scc1 F_p_pk2x
  s_mov_b64 exec, vcc
  s_cbranch_vccnz F_p_pk2
F_p_pk2x:
  s_mov_b64 exec, -1
  s_mov_b32 s37, 0x10000
  s_branch F_p_px2c
F_p_px2:
  buffer_load_dwordx2 v[16:17], off, s[4:7], s38 sc0 sc1
F_p_px2c:
  s_sub_u32 s37, s37, 1
  s_waitcnt vmcnt(0)
  v_cmp_ne_u32 vcc, s40, v16
  s_cbranch_scc1 F_p_px2x
  s_mov_b64 exec, vcc
  s_cbranch_vccnz F_p_px2
F_p_px2x:
  s_mov_b64 exec, -1
  s_setprio 3
  v_mov_b32 v18, v13
  v_mov_b32 v19, v14
  s_nop 0
  v_mov_b32_dpp v20, v18 quad_perm:[1,0,3,2] row_mask:0xf bank_mask:0xf
  v_mov_b32_dpp v21, v19 quad_perm:[1,0,3,2] row_mask:0xf bank_mask:0xf
  v_max_u32 v19, v19, v21
  v_med3_u32 v19, v18, v19, v20
  v_max_u32 v18, v18, v20
  s_nop 1
  v_mov_b32_dpp v20, v18 quad_perm:[2,3,0,1] row_mask:0xf bank_mask:0xf
  v_mov_b32_dpp v21, v19 quad_perm:[2,3,0,1] row_mask:0xf bank_mask:0xf
  v_max_u32 v19, v19, v21
  v_med3_u32 v19, v18, v19, v20
  v_max_u32 v18, v18, v20
  s_nop 1
  v_mov_b32_dpp v20, v18 row_half_mirror row_mask:0xf bank_mask:0xf
  v_mov_b32_dpp v21, v19 row_half_mirror row_mask:0xf bank_mask:0xf
  v_max_u32 v19, v19, v21
  v_med3_u32 v19, v18, v19, v20
  v_max_u32 v18, v18, v20
  s_nop 1
  v_mov_b32_dpp v20, v18 row_mirror row_mask:0xf bank_mask:0xf
  v_mov_b32_dpp v21, v19 row_mirror row_mask:0xf bank_mask:0xf
  v_max_u32 v19, v19, v21
  v_med3_u32 v19, v18, v19, v20
  v_max_u32 v18, v18, v20
  v_lshrrev_b32 v4, 4, v0
  v_lshlrev_b32 v4, 3, v4
  v_lshlrev_b32 v5, 3, v2
  ds_write_b64 v4, v[18:19] offset:57344
  s_waitcnt lgkmcnt(0)
  s_barrier
  ds_read_b64 v[18:19], v5 offset:57344
  s_waitcnt lgkmcnt(0)
  v_mov_b32_dpp v20, v18 quad_perm:[1,0,3,2] row_mask:0xf bank_mask:0xf
  v_mov_b32_dpp v21, v19 quad_perm:[1,0,3,2] row_mask:0xf bank_mask:0xf
  v_max_u32 v19, v19, v21
  v_med3_u32 v19, v18, v19, v20
  v_max_u32 v18, v18, v20
  s_nop 1
  v_mov_b32_dpp v20, v18 quad_perm:[2,3,0,1] row_mask:0xf bank_mask:0xf
  v_mov_b32_dpp v21, v19 quad_perm:[2,3,0,1] row_mask:0xf bank_mask:0xf
  v_max_u32 v19, v19, v21
  v_med3_u32 v19, v18, v19, v20
  v_max_u32 v18, v18, v20
  s_nop 1
  v_mov_b32_dpp v20, v18 row_half_mirror row_mask:0xf bank_mask:0xf
  v_mov_b32_dpp v21, v19 row_half_mirror row_mask:0xf bank_mask:0xf
  v_max_u32 v19, v19, v21
  v_med3_u32 v19, v18, v19, v20
  v_max_u32 v18, v18, v20
  s_nop 1
  v_mov_b32_dpp v20, v18 row_mirror row_mask:0xf bank_mask:0xf
  v_mov_b32_dpp v21, v19 row_mirror row_mask:0xf bank_mask:0xf
  v_max_u32 v19, v19, v21
  v_med3_u32 v19, v18, v19, v20
  v_max_u32 v18, v18, v20
  v_med3_u32 v19, v18, v19, v17
  v_max_u32 v18, v18, v17
  v_and_b32 v21, 0x73f, v19
  v_and_b32 v20, 0x73f, v18
  v_add_u32 v4, 64, v21
  v_cmp_eq_u32 vcc, v20, v21
  s_mov_b32 s36, 0x564000
  s_nop 0
  v_cndmask_b32 v21, v21, v4, vcc
  v_cndmask_b32 v20, v20, v21, s[52:53]
  v_mul_u32_u24 v11, 1152, v20
  v_add_u32 v5, v11, v6
  s_mov_b64 exec, s[54:55]
  s_mov_b32 s37, 0x10000
F_gr2:
  buffer_load_dwordx4 v[88:91], v5, s[4:7], s36 offen offset:0 sc0 sc1
  buffer_load_dwordx4 v[92:95], v5, s[4:7], s36 offen offset:64 sc0 sc1
  buffer_load_dwordx4 v[96:99], v5, s[4:7], s36 offen offset:128 sc0 sc1
  buffer_load_dwordx4 v[100:103], v5, s[4:7], s36 offen offset:192 sc0 sc1
  buffer_load_dwordx2 v[28:29], v11, s[4:7], s36 offen offset:1024 sc0 sc1
  s_sub_u32 s37, s37, 1
  s_waitcnt vmcnt(0)
  v_max3_u32 v4, v28, v88, v92
  v_max3_u32 v4, v4, v96, v100
  v_cmp_eq_u32 vcc, -1, v4
  s_cbranch_scc1 F_gr2x
  s_mov_b64 exec, vcc
  s_cbranch_vccnz F_gr2
F_gr2x:
  s_mov_b64 exec, -1
  v_mul_f32 v144, -v184, v28
  v_mul_f32 v145, -v185, v28
  v_mul_f32 v146, -v186, v28
  v_mul_f32 v147, -v187, v28
  v_mul_f32 v148, -v188, v28
  v_mul_f32 v149, -v189, v28
  v_mul_f32 v150, -v190, v28
  v_mul_f32 v151, -v191, v28
  v_mfma_f32_16x16x32_bf16 v[144:147], v[32:35], v[88:91], v[144:147]
  s_nop 0
  v_mfma_f32_16x16x32_bf16 v[148:151], v[48:51], v[88:91], v[148:151]
  v_mfma_f32_16x16x32_bf16 v[144:147], v[36:39], v[92:95], v[144:147]
  v_mfma_f32_16x16x32_bf16 v[148:151], v[52:55], v[92:95], v[148:151]
  v_mfma_f32_16x16x32_bf16 v[144:147], v[40:43], v[96:99], v[144:147]
  v_mfma_f32_16x16x32_bf16 v[148:151], v[56:59], v[96:99], v[148:151]
  v_mfma_f32_16x16x32_bf16 v[144:147], v[44:47], v[100:103], v[144:147]
  v_mfma_f32_16x16x32_bf16 v[148:151], v[60:63], v[100:103], v[148:151]
  s_mov_b64 exec, s[54:55]
  s_add_u32 s36, s23, 0xab3000
  s_cmp_ge_u32 s22, 1
  s_nop 3
  ds_write_b128 v8, v[144:147] offset:57472
  ds_write_b128 v8, v[148:151] offset:57600
  s_mov_b64 exec, -1
  v_mov_b32_dpp v20, v29 row_newbcast:0 row_mask:0xf bank_mask:0xf
  v_mov_b32_dpp v21, v29 row_newbcast:1 row_mask:0xf bank_mask:0xf
  s_mov_b64 exec, s[62:63]
  v_cndmask_b32 v21, v20, v21, s[52:53]
  v_mul_f32 v20, s27, v21
  v_mul_f32 v21, v21, v21
  s_waitcnt lgkmcnt(0)
  s_barrier
  s_cbranch_scc1 F_pn2
  ds_read_b128 v[144:147], v7 offset:57472
  ds_read_b128 v[148:151], v7 offset:57600
  ds_read_b128 v[160:163], v7 offset:57728
  ds_read_b128 v[164:167], v7 offset:57856
  ds_read_b128 v[168:171], v7 offset:57984
  ds_read_b128 v[172:175], v7 offset:58112
  ds_read_b128 v[176:179], v7 offset:58240
  ds_read_b128 v[180:183], v7 offset:58368
  s_waitcnt lgkmcnt(4)
  v_add_f32 v144, v144, v160
  v_add_f32 v145, v145, v161
  v_add_f32 v146, v146, v162
  v_add_f32 v147, v147, v163
  v_add_f32 v148, v148, v164
  v_add_f32 v149, v149, v165
  v_add_f32 v150, v150, v166
  v_add_f32 v151, v151, v167
  s_waitcnt lgkmcnt(2)
  v_add_f32 v144, v144, v168
  v_add_f32 v145, v145, v169
  v_add_f32 v146, v146, v170
  v_add_f32 v147, v147, v171
  v_add_f32 v148, v148, v172
  v_add_f32 v149, v149, v173
  v_add_f32 v150, v150, v174
  v_add_f32 v151, v151, v175
  s_waitcnt lgkmcnt(0)
  v_add_f32 v144, v144, v176
  v_add_f32 v145, v145, v177
  v_add_f32 v146, v146, v178
  v_add_f32 v147, v147, v179
  v_add_f32 v148, v148, v180
  v_add_f32 v149, v149, v181
  v_add_f32 v150, v150, v182
  v_add_f32 v151, v151, v183
  v_mul_f32 v152, v20, v144
  v_mul_f32 v153, v20, v145
  v_mul_f32 v154, v20, v146
  v_mul_f32 v155, v20, v147
  v_exp_f32 v152, v152
  v_mul_f32 v144, v144, v148
  v_exp_f32 v153, v153
  v_mul_f32 v145, v145, v149
  v_exp_f32 v154, v154
  v_mul_f32 v146, v146, v150
  v_exp_f32 v155, v155
  v_mul_f32 v147, v147, v151
  v_add_f32 v152, 1.0, v152
  v_add_f32 v153, 1.0, v153
  v_add_f32 v154, 1.0, v154
  v_add_f32 v155, 1.0, v155
  v_rcp_f32 v152, v152
  v_mul_f32 v144, v144, v21
  v_rcp_f32 v153, v153
  v_mul_f32 v145, v145, v21
  v_rcp_f32 v154, v154
  v_mul_f32 v146, v146, v21
  v_rcp_f32 v155, v155
  v_mul_f32 v147, v147, v21
  v_mul_f32 v144, v144, v152
  v_mul_f32 v145, v145, v153
  v_mul_f32 v146, v146, v154
  v_mul_f32 v147, v147, v155
  v_cvt_pk_bf16_f32 v18, v144, v145
  v_cvt_pk_bf16_f32 v19, v146, v147
  buffer_store_dwordx2 v[18:19], v10, s[4:7], s36 offen sc0 sc1
F_pn2:
  s_mov_b64 exec, -1
  s_setprio 0
  s_endpgm
WENDC:
F_cons:
  s_lshl_b32 s23, s20, 7
  s_lshl_b32 s24, s21, 5
  s_add_u32 s23, s23, s24
  s_mul_i32 s24, s22, 458752
  s_add_u32 s24, s24, s23
  v_lshl_add_u32 v6, v4, 10, v5
  s_mov_b32 s12, s50
  s_mov_b32 s13, s51
  s_mov_b32 s14, 0x1c0000
  s_mov_b32 s15, 0x20000
  s_cmp_lt_u32 s3, 160
  s_cbranch_scc1 F_cons2
  s_sub_u32 s36, s3, 160
  s_lshr_b32 s36, s36, 3
  s_lshl_b32 s36, s36, 2
  s_add_u32 s36, s36, s22
  s_mul_i32 s36, s36, 41984
  s_lshl_b32 s37, s20, 7
  s_add_u32 s36, s36, s37
  s_add_u32 s37, s36, 21504
  v_mul_u32_u24 v10, 3, v5
  v_add_u32 v10, v10, v6
  buffer_load_dword v88, v10, s[12:15], s36 offen
  s_waitcnt vmcnt(0)
  buffer_load_dword v89, v10, s[12:15], s37 offen
  s_waitcnt vmcnt(0)
  s_endpgm
  .p2align 12
F_cons2:
  s_mov_b32 s37, 64
  F_wc:
  s_memrealtime s[98:99]
  s_sub_u32 s37, s37, 1
  s_cbranch_scc1 F_wcx
  s_waitcnt lgkmcnt(0)
  s_sub_u32 s98, s98, s96
  s_cmp_ge_u32 s98, 300
  s_cbranch_scc1 F_wcx
  s_sleep 2
  s_branch F_wc
  F_wcx:
  buffer_load_dwordx4 v[88:91], v6, s[12:15], s24 offen
  s_waitcnt vmcnt(1)
  s_add_u32 s24, s24, 32768
  buffer_load_dwordx4 v[92:95], v6, s[12:15], s24 offen
  s_waitcnt vmcnt(1)
  s_add_u32 s24, s24, 32768
  buffer_load_dwordx4 v[96:99], v6, s[12:15], s24 offen
  s_waitcnt vmcnt(1)
  s_add_u32 s24, s24, 32768
  buffer_load_dwordx4 v[100:103], v6, s[12:15], s24 offen
  s_waitcnt vmcnt(1)
  s_add_u32 s24, s24, 32768
  buffer_load_dwordx4 v[104:107], v6, s[12:15], s24 offen
  s_waitcnt vmcnt(1)
  s_add_u32 s24, s24, 32768
  buffer_load_dwordx4 v[108:111], v6, s[12:15], s24 offen
  s_waitcnt vmcnt(1)
  s_add_u32 s24, s24, 32768
  buffer_load_dwordx4 v[112:115], v6, s[12:15], s24 offen
  s_waitcnt vmcnt(1)
  s_add_u32 s24, s24, 32768
  buffer_load_dwordx4 v[116:119], v6, s[12:15], s24 offen
  s_waitcnt vmcnt(1)
  s_add_u32 s24, s24, 32768
  buffer_load_dwordx4 v[120:123], v6, s[12:15], s24 offen
  s_waitcnt vmcnt(1)
  s_add_u32 s24, s24, 32768
  buffer_load_dwordx4 v[124:127], v6, s[12:15], s24 offen
  s_waitcnt vmcnt(1)
  s_add_u32 s24, s24, 32768
  buffer_load_dwordx4 v[128:131], v6, s[12:15], s24 offen
  s_waitcnt vmcnt(1)
  s_add_u32 s24, s24, 32768
  buffer_load_dwordx4 v[132:135], v6, s[12:15], s24 offen
  s_waitcnt vmcnt(1)
  s_add_u32 s24, s24, 32768
  buffer_load_dwordx4 v[136:139], v6, s[12:15], s24 offen
  s_waitcnt vmcnt(1)
  s_add_u32 s24, s24, 32768
  buffer_load_dwordx4 v[140:143], v6, s[12:15], s24 offen
  s_waitcnt vmcnt(1)
  s_mul_i32 s25, s22, 14336
  v_add_u32 v7, s25, v7
  v_add_u32 v8, s25, v8
  s_waitcnt vmcnt(0)
  ds_write_b128 v8, v[88:91] offset:0
  ds_write_b128 v8, v[92:95] offset:1024
  ds_write_b128 v8, v[96:99] offset:2048
  ds_write_b128 v8, v[100:103] offset:3072
  ds_write_b128 v8, v[104:107] offset:4096
  ds_write_b128 v8, v[108:111] offset:5120
  ds_write_b128 v8, v[112:115] offset:6144
  ds_write_b128 v8, v[116:119] offset:7168
  ds_write_b128 v8, v[120:123] offset:8192
  ds_write_b128 v8, v[124:127] offset:9216
  ds_write_b128 v8, v[128:131] offset:10240
  ds_write_b128 v8, v[132:135] offset:11264
  ds_write_b128 v8, v[136:139] offset:12288
  ds_write_b128 v8, v[140:143] offset:13312
  s_waitcnt lgkmcnt(0)
  s_mul_i32 s40, s40, 0x9e3779b1
  s_add_u32 s40, s40, 0x7f4a7c15
  ds_read_b64_tr_b16 v[32:33], v7 offset:0
  ds_read_b64_tr_b16 v[34:35], v7 offset:128
  ds_read_b64_tr_b16 v[36:37], v7 offset:1024
  ds_read_b64_tr_b16 v[38:39], v7 offset:1152
  ds_read_b64_tr_b16 v[40:41], v7 offset:2048
  ds_read_b64_tr_b16 v[42:43], v7 offset:2176
  ds_read_b64_tr_b16 v[44:45], v7 offset:3072
  ds_read_b64_tr_b16 v[46:47], v7 offset:3200
  ds_read_b64_tr_b16 v[48:49], v7 offset:4096
  ds_read_b64_tr_b16 v[50:51], v7 offset:4224
  ds_read_b64_tr_b16 v[52:53], v7 offset:5120
  ds_read_b64_tr_b16 v[54:55], v7 offset:5248
  ds_read_b64_tr_b16 v[56:57], v7 offset:6144
  ds_read_b64_tr_b16 v[58:59], v7 offset:6272
  ds_read_b64_tr_b16 v[60:61], v7 offset:7168
  ds_read_b64_tr_b16 v[62:63], v7 offset:7296
  ds_read_b64_tr_b16 v[64:65], v7 offset:8192
  ds_read_b64_tr_b16 v[66:67], v7 offset:8320
  ds_read_b64_tr_b16 v[68:69], v7 offset:9216
  ds_read_b64_tr_b16 v[70:71], v7 offset:9344
  ds_read_b64_tr_b16 v[72:73], v7 offset:10240
  ds_read_b64_tr_b16 v[74:75], v7 offset:10368
  ds_read_b64_tr_b16 v[76:77], v7 offset:11264
  ds_read_b64_tr_b16 v[78:79], v7 offset:11392
  ds_read_b64_tr_b16 v[80:81], v7 offset:12288
  ds_read_b64_tr_b16 v[82:83], v7 offset:12416
  ds_read_b64_tr_b16 v[84:85], v7 offset:13312
  ds_read_b64_tr_b16 v[86:87], v7 offset:13440
  v_mov_b32 v88, 0
  v_mov_b32 v89, 0
  v_mov_b32 v90, 0
  v_mov_b32 v91, 0
  v_mov_b32 v92, 0
  v_mov_b32 v93, 0
  v_mov_b32 v94, 0
  v_mov_b32 v95, 0
  v_mov_b32 v96, 0
  v_mov_b32 v97, 0
  v_mov_b32 v98, 0
  v_mov_b32 v99, 0
  v_mov_b32 v100, 0
  v_mov_b32 v101, 0
  v_mov_b32 v102, 0
  v_mov_b32 v103, 0
  v_mov_b32 v104, 0
  v_mov_b32 v105, 0
  v_mov_b32 v106, 0
  v_mov_b32 v107, 0
  v_mov_b32 v108, 0
  v_mov_b32 v109, 0
  v_mov_b32 v110, 0
  v_mov_b32 v111, 0
  v_mov_b32 v112, 0
  v_mov_b32 v113, 0
  v_mov_b32 v114, 0
  v_mov_b32 v115, 0
  v_mov_b32 v116, 0
  v_mov_b32 v117, 0
  v_mov_b32 v118, 0
  v_mov_b32 v119, 0
  v_mov_b32 v120, 0
  v_mov_b32 v121, 0
  v_mov_b32 v122, 0
  v_mov_b32 v123, 0
  v_mov_b32 v124, 0
  v_mov_b32 v125, 0
  v_mov_b32 v126, 0
  v_mov_b32 v127, 0
  v_mov_b32 v128, 0
  v_mov_b32 v129, 0
  v_mov_b32 v130, 0
  v_mov_b32 v131, 0
  v_mov_b32 v132, 0
  v_mov_b32 v133, 0
  v_mov_b32 v134, 0
  v_mov_b32 v135, 0
  v_mov_b32 v136, 0
  v_mov_b32 v137, 0
  v_mov_b32 v138, 0
  v_mov_b32 v139, 0
  v_mov_b32 v140, 0
  v_mov_b32 v141, 0
  v_mov_b32 v142, 0
  v_mov_b32 v143, 0
  v_lshrrev_b32 v4, 1, v3
  v_and_b32 v5, 1, v3
  v_lshlrev_b32 v6, 7, v4
  v_lshl_add_u32 v6, v5, 4, v6
  v_lshl_add_u32 v6, v2, 5, v6
  s_waitcnt lgkmcnt(0)
  v_lshlrev_b32 v7, 6, v2
  v_lshl_add_u32 v7, v3, 4, v7
  s_lshl_b32 s26, s22, 7
  v_add_u32 v8, s26, v7
  v_and_b32 v7, 127, v7
  v_lshrrev_b32 v4, 1, v2
  v_mul_u32_u24 v4, 4352, v4
  v_add_u32 v10, v7, v4
  v_cmp_gt_u32 s[62:63], 16, v2
  s_mov_b32 s37, 0x10000
  s_branch F_c_g1
F_c_g1s:
  s_sleep 2
F_c_g1:
  buffer_load_dword v12, off, s[4:7], s61 offset:0 sc0 sc1
  s_sub_u32 s37, s37, 1
  s_waitcnt vmcnt(0)
  v_cmp_ne_u32 vcc, s40, v12
  s_cbranch_scc1 F_c_g1x
  s_mov_b64 exec, vcc
  s_cbranch_vccnz F_c_g1s
F_c_g1x:
  s_mov_b64 exec, -1
  s_sleep 6
  s_and_b32 s36, s3, 3
  s_mul_i32 s36, s36, 4224
  s_add_u32 s36, s36, 0x800000
  s_add_u32 s38, s36, 4096
  buffer_load_dwordx2 v[16:17], off, s[4:7], s38 sc0 sc1
  s_mov_b32 s37, 0x10000
F_c_pk1:
  buffer_load_dwordx3 v[12:14], v9, s[4:7], s36 offen sc0 sc1
  s_sub_u32 s37, s37, 1
  s_waitcnt vmcnt(0)
  v_cmp_ne_u32 vcc, s40, v12
  s_cbranch_scc1 F_c_pk1x
  s_mov_b64 exec, vcc
  s_cbranch_vccnz F_c_pk1
F_c_pk1x:
  s_mov_b64 exec, -1
  s_mov_b32 s37, 0x10000
  s_branch F_c_px1c
F_c_px1:
  buffer_load_dwordx2 v[16:17], off, s[4:7], s38 sc0 sc1
F_c_px1c:
  s_sub_u32 s37, s37, 1
  s_waitcnt vmcnt(0)
  v_cmp_ne_u32 vcc, s40, v16
  s_cbranch_scc1 F_c_px1x
  s_mov_b64 exec, vcc
  s_cbranch_vccnz F_c_px1
F_c_px1x:
  s_mov_b64 exec, -1
  s_setprio 3
  v_mov_b32 v18, v13
  v_mov_b32 v19, v14
  s_nop 0
  v_mov_b32_dpp v20, v18 quad_perm:[1,0,3,2] row_mask:0xf bank_mask:0xf
  v_mov_b32_dpp v21, v19 quad_perm:[1,0,3,2] row_mask:0xf bank_mask:0xf
  v_max_u32 v19, v19, v21
  v_med3_u32 v19, v18, v19, v20
  v_max_u32 v18, v18, v20
  s_nop 1
  v_mov_b32_dpp v20, v18 quad_perm:[2,3,0,1] row_mask:0xf bank_mask:0xf
  v_mov_b32_dpp v21, v19 quad_perm:[2,3,0,1] row_mask:0xf bank_mask:0xf
  v_max_u32 v19, v19, v21
  v_med3_u32 v19, v18, v19, v20
  v_max_u32 v18, v18, v20
  s_nop 1
  v_mov_b32_dpp v20, v18 row_half_mirror row_mask:0xf bank_mask:0xf
  v_mov_b32_dpp v21, v19 row_half_mirror row_mask:0xf bank_mask:0xf
  v_max_u32 v19, v19, v21
  v_med3_u32 v19, v18, v19, v20
  v_max_u32 v18, v18, v20
  s_nop 1
  v_mov_b32_dpp v20, v18 row_mirror row_mask:0xf bank_mask:0xf
  v_mov_b32_dpp v21, v19 row_mirror row_mask:0xf bank_mask:0xf
  v_max_u32 v19, v19, v21
  v_med3_u32 v19, v18, v19, v20
  v_max_u32 v18, v18, v20
  v_lshrrev_b32 v4, 4, v0
  v_lshlrev_b32 v4, 3, v4
  v_lshlrev_b32 v5, 3, v2
  ds_write_b64 v4, v[18:19] offset:57344
  s_waitcnt lgkmcnt(0)
  s_barrier
  ds_read_b64 v[18:19], v5 offset:57344
  s_waitcnt lgkmcnt(0)
  v_mov_b32_dpp v20, v18 quad_perm:[1,0,3,2] row_mask:0xf bank_mask:0xf
  v_mov_b32_dpp v21, v19 quad_perm:[1,0,3,2] row_mask:0xf bank_mask:0xf
  v_max_u32 v19, v19, v21
  v_med3_u32 v19, v18, v19, v20
  v_max_u32 v18, v18, v20
  s_nop 1
  v_mov_b32_dpp v20, v18 quad_perm:[2,3,0,1] row_mask:0xf bank_mask:0xf
  v_mov_b32_dpp v21, v19 quad_perm:[2,3,0,1] row_mask:0xf bank_mask:0xf
  v_max_u32 v19, v19, v21
  v_med3_u32 v19, v18, v19, v20
  v_max_u32 v18, v18, v20
  s_nop 1
  v_mov_b32_dpp v20, v18 row_half_mirror row_mask:0xf bank_mask:0xf
  v_mov_b32_dpp v21, v19 row_half_mirror row_mask:0xf bank_mask:0xf
  v_max_u32 v19, v19, v21
  v_med3_u32 v19, v18, v19, v20
  v_max_u32 v18, v18, v20
  s_nop 1
  v_mov_b32_dpp v20, v18 row_mirror row_mask:0xf bank_mask:0xf
  v_mov_b32_dpp v21, v19 row_mirror row_mask:0xf bank_mask:0xf
  v_max_u32 v19, v19, v21
  v_med3_u32 v19, v18, v19, v20
  v_max_u32 v18, v18, v20
  v_med3_u32 v19, v18, v19, v17
  v_max_u32 v18, v18, v17
  v_and_b32 v21, 0x73f, v19
  v_and_b32 v20, 0x73f, v18
  v_add_u32 v4, 64, v21
  v_cmp_eq_u32 vcc, v20, v21
  s_mov_b32 s36, 0x540000
  s_nop 0
  v_cndmask_b32 v21, v21, v4, vcc
  v_cndmask_b32 v20, v20, v21, s[52:53]
  v_mul_u32_u24 v11, 1152, v20
  s_mov_b64 exec, -1
  s_mov_b32 s37, 0x10000
  s_branch F_gs1
F_gs1s:
  s_sleep 1
F_gs1:
  buffer_load_dwordx4 v[28:31], v11, s[4:7], s36 offen offset:1024 sc0 sc1
  s_sub_u32 s37, s37, 1
  s_waitcnt vmcnt(0)
  v_max_u32 v4, v28, v30
  v_cmp_eq_u32 vcc, -1, v4
  s_cbranch_scc1 F_gs1x
  s_mov_b64 exec, vcc
  s_cbranch_vccnz F_gs1s
F_gs1x:
  s_mov_b64 exec, -1
  s_and_b32 s26, s3, 7
  s_lshl_b32 s26, s26, 2
  s_add_u32 s26, s26, s22
  s_mul_i32 s26, s26, 4352
  s_add_u32 s26, s26, 0xa91000
  v_mul_f32 v20, s27, v30
  v_exp_f32 v20, v20
  v_and_b32 v25, 0xffff0000, v23
  v_lshlrev_b32 v24, 16, v23
  v_add_f32 v20, 1.0, v20
  v_and_b32 v23, 0xffff0000, v22
  v_lshlrev_b32 v22, 16, v22
  v_rcp_f32 v20, v20
  s_mov_b64 exec, s[54:55]
  s_sleep 26
  s_mov_b32 s37, 0x10000
F_gh1:
  buffer_load_dwordx4 v[88:91], v6, s[4:7], s26 offen offset:0 sc0 sc1
  buffer_load_dwordx4 v[92:95], v6, s[4:7], s26 offen offset:256 sc0 sc1
  buffer_load_dwordx4 v[96:99], v6, s[4:7], s26 offen offset:512 sc0 sc1
  buffer_load_dwordx4 v[100:103], v6, s[4:7], s26 offen offset:768 sc0 sc1
  buffer_load_dwordx4 v[104:107], v6, s[4:7], s26 offen offset:1024 sc0 sc1
  buffer_load_dwordx4 v[108:111], v6, s[4:7], s26 offen offset:1280 sc0 sc1
  buffer_load_dwordx4 v[112:115], v6, s[4:7], s26 offen offset:1536 sc0 sc1
  buffer_load_dwordx4 v[116:119], v6, s[4:7], s26 offen offset:1792 sc0 sc1
  buffer_load_dwordx4 v[120:123], v6, s[4:7], s26 offen offset:2048 sc0 sc1
  buffer_load_dwordx4 v[124:127], v6, s[4:7], s26 offen offset:2304 sc0 sc1
  buffer_load_dwordx4 v[128:131], v6, s[4:7], s26 offen offset:2560 sc0 sc1
  buffer_load_dwordx4 v[132:135], v6, s[4:7], s26 offen offset:2816 sc0 sc1
  buffer_load_dwordx4 v[136:139], v6, s[4:7], s26 offen offset:3072 sc0 sc1
  buffer_load_dwordx4 v[140:143], v6, s[4:7], s26 offen offset:3328 sc0 sc1
  s_sub_u32 s37, s37, 1
  s_waitcnt vmcnt(0)
  v_max_u32 v4, v88, v90
  v_max3_u32 v4, v4, v92, v94
  v_max3_u32 v4, v4, v96, v98
  v_max3_u32 v4, v4, v100, v102
  v_max3_u32 v4, v4, v104, v106
  v_max3_u32 v4, v4, v108, v110
  v_max3_u32 v4, v4, v112, v114
  v_max3_u32 v4, v4, v116, v118
  v_max3_u32 v4, v4, v120, v122
  v_max3_u32 v4, v4, v124, v126
  v_max3_u32 v4, v4, v128, v130
  v_max3_u32 v4, v4, v132, v134
  v_max3_u32 v4, v4, v136, v138
  v_max3_u32 v4, v4, v140, v142
  v_cmp_eq_u32 vcc, -1, v4
  s_cbranch_scc1 F_gh1x
  s_mov_b64 exec, vcc
  s_cbranch_vccnz F_gh1
F_gh1x:
  s_mov_b64 exec, -1
  v_mfma_f32_16x16x32_bf16 v[144:147], v[32:35], v[88:91], 0
  v_mfma_f32_16x16x32_bf16 v[148:151], v[36:39], v[92:95], 0
  v_mfma_f32_16x16x32_bf16 v[144:147], v[40:43], v[96:99], v[144:147]
  v_mfma_f32_16x16x32_bf16 v[148:151], v[44:47], v[100:103], v[148:151]
  v_mfma_f32_16x16x32_bf16 v[144:147], v[48:51], v[104:107], v[144:147]
  v_mfma_f32_16x16x32_bf16 v[148:151], v[52:55], v[108:111], v[148:151]
  v_mfma_f32_16x16x32_bf16 v[144:147], v[56:59], v[112:115], v[144:147]
  v_mfma_f32_16x16x32_bf16 v[148:151], v[60:63], v[116:119], v[148:151]
  v_mfma_f32_16x16x32_bf16 v[144:147], v[64:67], v[120:123], v[144:147]
  v_mfma_f32_16x16x32_bf16 v[148:151], v[68:71], v[124:127], v[148:151]
  v_mfma_f32_16x16x32_bf16 v[144:147], v[72:75], v[128:131], v[144:147]
  v_mfma_f32_16x16x32_bf16 v[148:151], v[76:79], v[132:135], v[148:151]
  v_mfma_f32_16x16x32_bf16 v[144:147], v[80:83], v[136:139], v[144:147]
  v_mfma_f32_16x16x32_bf16 v[148:151], v[84:87], v[140:143], v[148:151]
  s_lshl_b32 s36, s23, 2
  s_mul_i32 s37, s22, 34816
  s_add_u32 s36, s36, s37
  s_add_u32 s36, s36, 0xa80000
  s_cmp_ge_u32 s22, 2
  s_nop 2
  v_add_f32 v144, v144, v148
  v_add_f32 v145, v145, v149
  v_add_f32 v146, v146, v150
  v_add_f32 v147, v147, v151
  s_mov_b64 exec, s[54:55]
  ds_write_b128 v8, v[144:147] offset:57472
  s_waitcnt lgkmcnt(0)
  s_barrier
  s_cbranch_scc1 F_cn1
  s_mov_b64 exec, s[62:63]
  ds_read_b128 v[144:147], v7 offset:57472
  ds_read_b128 v[156:159], v7 offset:57600
  ds_read_b128 v[160:163], v7 offset:57728
  ds_read_b128 v[164:167], v7 offset:57856
  s_waitcnt lgkmcnt(2)
  v_add_f32 v144, v144, v156
  v_add_f32 v145, v145, v157
  v_add_f32 v146, v146, v158
  v_add_f32 v147, v147, v159
  s_waitcnt lgkmcnt(1)
  v_add_f32 v144, v144, v160
  v_add_f32 v145, v145, v161
  v_add_f32 v146, v146, v162
  v_add_f32 v147, v147, v163
  s_waitcnt lgkmcnt(0)
  v_add_f32 v144, v144, v164
  v_add_f32 v145, v145, v165
  v_add_f32 v146, v146, v166
  v_add_f32 v147, v147, v167
  v_mul_f32 v144, v144, v20
  v_mul_f32 v145, v145, v20
  v_mul_f32 v146, v146, v20
  v_mul_f32 v147, v147, v20
  buffer_store_dwordx4 v[144:147], v10, s[4:7], s36 offen sc0 sc1
F_cn1:
  s_mov_b64 exec, -1
  s_setprio 0
  s_mov_b32 s37, 0x10000
  s_branch F_c_g2
F_c_g2s:
  s_sleep 2
F_c_g2:
  buffer_load_dword v12, off, s[4:7], s61 offset:1024 sc0 sc1
  s_sub_u32 s37, s37, 1
  s_waitcnt vmcnt(0)
  v_cmp_ne_u32 vcc, s40, v12
  s_cbranch_scc1 F_c_g2x
  s_mov_b64 exec, vcc
  s_cbranch_vccnz F_c_g2s
F_c_g2x:
  s_mov_b64 exec, -1
  s_sleep 6
  s_and_b32 s36, s3, 3
  s_mul_i32 s36, s36, 4224
  s_add_u32 s36, s36, 0x940000
  s_add_u32 s38, s36, 4096
  buffer_load_dwordx2 v[16:17], off, s[4:7], s38 sc0 sc1
  s_mov_b32 s37, 0x10000
F_c_pk2:
  buffer_load_dwordx3 v[12:14], v9, s[4:7], s36 offen sc0 sc1
  s_sub_u32 s37, s37, 1
  s_waitcnt vmcnt(0)
  v_cmp_ne_u32 vcc, s40, v12
  s_cbranch_scc1 F_c_pk2x
  s_mov_b64 exec, vcc
  s_cbranch_vccnz F_c_pk2
F_c_pk2x:
  s_mov_b64 exec, -1
  s_mov_b32 s37, 0x10000
  s_branch F_c_px2c
F_c_px2:
  buffer_load_dwordx2 v[16:17], off, s[4:7], s38 sc0 sc1
F_c_px2c:
  s_sub_u32 s37, s37, 1
  s_waitcnt vmcnt(0)
  v_cmp_ne_u32 vcc, s40, v16
  s_cbranch_scc1 F_c_px2x
  s_mov_b64 exec, vcc
  s_cbranch_vccnz F_c_px2
F_c_px2x:
  s_mov_b64 exec, -1
  s_setprio 3
  v_mov_b32 v18, v13
  v_mov_b32 v19, v14
  s_nop 0
  v_mov_b32_dpp v20, v18 quad_perm:[1,0,3,2] row_mask:0xf bank_mask:0xf
  v_mov_b32_dpp v21, v19 quad_perm:[1,0,3,2] row_mask:0xf bank_mask:0xf
  v_max_u32 v19, v19, v21
  v_med3_u32 v19, v18, v19, v20
  v_max_u32 v18, v18, v20
  s_nop 1
  v_mov_b32_dpp v20, v18 quad_perm:[2,3,0,1] row_mask:0xf bank_mask:0xf
  v_mov_b32_dpp v21, v19 quad_perm:[2,3,0,1] row_mask:0xf bank_mask:0xf
  v_max_u32 v19, v19, v21
  v_med3_u32 v19, v18, v19, v20
  v_max_u32 v18, v18, v20
  s_nop 1
  v_mov_b32_dpp v20, v18 row_half_mirror row_mask:0xf bank_mask:0xf
  v_mov_b32_dpp v21, v19 row_half_mirror row_mask:0xf bank_mask:0xf
  v_max_u32 v19, v19, v21
  v_med3_u32 v19, v18, v19, v20
  v_max_u32 v18, v18, v20
  s_nop 1
  v_mov_b32_dpp v20, v18 row_mirror row_mask:0xf bank_mask:0xf
  v_mov_b32_dpp v21, v19 row_mirror row_mask:0xf bank_mask:0xf
  v_max_u32 v19, v19, v21
  v_med3_u32 v19, v18, v19, v20
  v_max_u32 v18, v18, v20
  v_lshrrev_b32 v4, 4, v0
  v_lshlrev_b32 v4, 3, v4
  v_lshlrev_b32 v5, 3, v2
  ds_write_b64 v4, v[18:19] offset:57344
  s_waitcnt lgkmcnt(0)
  s_barrier
  ds_read_b64 v[18:19], v5 offset:57344
  s_waitcnt lgkmcnt(0)
  v_mov_b32_dpp v20, v18 quad_perm:[1,0,3,2] row_mask:0xf bank_mask:0xf
  v_mov_b32_dpp v21, v19 quad_perm:[1,0,3,2] row_mask:0xf bank_mask:0xf
  v_max_u32 v19, v19, v21
  v_med3_u32 v19, v18, v19, v20
  v_max_u32 v18, v18, v20
  s_nop 1
  v_mov_b32_dpp v20, v18 quad_perm:[2,3,0,1] row_mask:0xf bank_mask:0xf
  v_mov_b32_dpp v21, v19 quad_perm:[2,3,0,1] row_mask:0xf bank_mask:0xf
  v_max_u32 v19, v19, v21
  v_med3_u32 v19, v18, v19, v20
  v_max_u32 v18, v18, v20
  s_nop 1
  v_mov_b32_dpp v20, v18 row_half_mirror row_mask:0xf bank_mask:0xf
  v_mov_b32_dpp v21, v19 row_half_mirror row_mask:0xf bank_mask:0xf
  v_max_u32 v19, v19, v21
  v_med3_u32 v19, v18, v19, v20
  v_max_u32 v18, v18, v20
  s_nop 1
  v_mov_b32_dpp v20, v18 row_mirror row_mask:0xf bank_mask:0xf
  v_mov_b32_dpp v21, v19 row_mirror row_mask:0xf bank_mask:0xf
  v_max_u32 v19, v19, v21
  v_med3_u32 v19, v18, v19, v20
  v_max_u32 v18, v18, v20
  v_med3_u32 v19, v18, v19, v17
  v_max_u32 v18, v18, v17
  v_and_b32 v21, 0x73f, v19
  v_and_b32 v20, 0x73f, v18
  v_add_u32 v4, 64, v21
  v_cmp_eq_u32 vcc, v20, v21
  s_mov_b32 s36, 0x564000
  s_nop 0
  v_cndmask_b32 v21, v21, v4, vcc
  v_cndmask_b32 v20, v20, v21, s[52:53]
  v_mul_u32_u24 v11, 1152, v20
  s_mov_b64 exec, s[54:55]
  v_cndmask_b32 v18, v18, v19, s[52:53]
  s_add_u32 s38, s36, s23
  v_lshl_add_u32 v5, v3, 3, v11
  v_and_b32 v20, 2047, v18
  v_sub_u32 v21, 2048, v20
  v_and_b32 v4, 2048, v18
  v_cmp_ne_u32 vcc, 0, v4
  v_and_b32 v1, 63, v20
  s_nop 0
  v_cndmask_b32 v10, v20, v21, vcc
  v_lshlrev_b32 v10, 10, v10
  v_lshl_add_u32 v10, v3, 3, v10
  v_cmp_eq_u32 vcc, 32, v1
  v_lshlrev_b32 v1, 3, v1
  s_nop 0
  v_cndmask_b32 v1, v1, 4, vcc
  v_lshrrev_b32 v21, 8, v20
  v_add_u32 v1, v1, v21
  v_mov_b32 v21, 256
  v_cmp_eq_u32 vcc, 0x400, v20
  s_nop 1
  v_cndmask_b32 v1, v1, v21, vcc
  v_lshlrev_b32 v1, 7, v1
  s_mov_b32 s37, 0x10000
  s_branch F_gs2
F_gs2s:
  s_sleep 1
F_gs2:
  buffer_load_dwordx4 v[28:31], v11, s[4:7], s36 offen offset:1024 sc0 sc1
  buffer_load_dwordx2 v[22:23], v5, s[4:7], s38 offen sc0 sc1
  s_sub_u32 s37, s37, 1
  s_waitcnt vmcnt(0)
  v_max_u32 v4, v28, v30
  v_max3_u32 v4, v4, v22, v23
  v_cmp_eq_u32 vcc, -1, v4
  s_cbranch_scc1 F_gs2x
  s_mov_b64 exec, vcc
  s_cbranch_vccnz F_gs2s
F_gs2x:
  s_mov_b64 exec, s[54:55]
  s_and_b32 s26, s3, 7
  s_lshl_b32 s26, s26, 2
  s_add_u32 s26, s26, s22
  s_mul_i32 s26, s26, 4352
  s_add_u32 s26, s26, 0xab3000
  v_mul_f32 v20, s27, v30
  v_exp_f32 v20, v20
  v_and_b32 v25, 0xffff0000, v23
  v_lshlrev_b32 v24, 16, v23
  v_add_f32 v20, 1.0, v20
  v_and_b32 v23, 0xffff0000, v22
  v_lshlrev_b32 v22, 16, v22
  v_rcp_f32 v20, v20
  s_mov_b64 exec, s[54:55]
  s_mov_b32 s36, 0x790040
  s_mov_b32 s37, 0x10000
  s_branch F_gd
F_gds:
  s_sleep 1
F_gd:
  buffer_load_dword v12, v1, s[4:7], s36 offen sc0 sc1
  s_sub_u32 s37, s37, 1
  s_waitcnt vmcnt(0)
  v_cmp_ne_u32 vcc, s40, v12
  s_cbranch_scc1 F_gdx
  s_mov_b64 exec, vcc
  s_cbranch_vccnz F_gds
F_gdx:
  s_mov_b64 exec, s[54:55]
  s_sleep 14
  s_mov_b32 s37, 0x10000
F_gh2:
  buffer_load_dwordx4 v[88:91], v6, s[4:7], s26 offen offset:0 sc0 sc1
  buffer_load_dwordx4 v[92:95], v6, s[4:7], s26 offen offset:256 sc0 sc1
  buffer_load_dwordx4 v[96:99], v6, s[4:7], s26 offen offset:512 sc0 sc1
  buffer_load_dwordx4 v[100:103], v6, s[4:7], s26 offen offset:768 sc0 sc1
  buffer_load_dwordx4 v[104:107], v6, s[4:7], s26 offen offset:1024 sc0 sc1
  buffer_load_dwordx4 v[108:111], v6, s[4:7], s26 offen offset:1280 sc0 sc1
  buffer_load_dwordx4 v[112:115], v6, s[4:7], s26 offen offset:1536 sc0 sc1
  buffer_load_dwordx4 v[116:119], v6, s[4:7], s26 offen offset:1792 sc0 sc1
  buffer_load_dwordx4 v[120:123], v6, s[4:7], s26 offen offset:2048 sc0 sc1
  buffer_load_dwordx4 v[124:127], v6, s[4:7], s26 offen offset:2304 sc0 sc1
  buffer_load_dwordx4 v[128:131], v6, s[4:7], s26 offen offset:2560 sc0 sc1
  buffer_load_dwordx4 v[132:135], v6, s[4:7], s26 offen offset:2816 sc0 sc1
  buffer_load_dwordx4 v[136:139], v6, s[4:7], s26 offen offset:3072 sc0 sc1
  buffer_load_dwordx4 v[140:143], v6, s[4:7], s26 offen offset:3328 sc0 sc1
  s_sub_u32 s37, s37, 1
  s_waitcnt vmcnt(0)
  v_max_u32 v4, v88, v90
  v_max3_u32 v4, v4, v92, v94
  v_max3_u32 v4, v4, v96, v98
  v_max3_u32 v4, v4, v100, v102
  v_max3_u32 v4, v4, v104, v106
  v_max3_u32 v4, v4, v108, v110
  v_max3_u32 v4, v4, v112, v114
  v_max3_u32 v4, v4, v116, v118
  v_max3_u32 v4, v4, v120, v122
  v_max3_u32 v4, v4, v124, v126
  v_max3_u32 v4, v4, v128, v130
  v_max3_u32 v4, v4, v132, v134
  v_max3_u32 v4, v4, v136, v138
  v_max3_u32 v4, v4, v140, v142
  v_cmp_eq_u32 vcc, -1, v4
  s_cbranch_scc1 F_gh2x
  s_mov_b64 exec, vcc
  s_cbranch_vccnz F_gh2
F_gh2x:
  s_mov_b64 exec, -1
  v_mfma_f32_16x16x32_bf16 v[144:147], v[32:35], v[88:91], 0
  v_mfma_f32_16x16x32_bf16 v[148:151], v[36:39], v[92:95], 0
  v_mfma_f32_16x16x32_bf16 v[144:147], v[40:43], v[96:99], v[144:147]
  v_mfma_f32_16x16x32_bf16 v[148:151], v[44:47], v[100:103], v[148:151]
  v_mfma_f32_16x16x32_bf16 v[144:147], v[48:51], v[104:107], v[144:147]
  v_mfma_f32_16x16x32_bf16 v[148:151], v[52:55], v[108:111], v[148:151]
  v_mfma_f32_16x16x32_bf16 v[144:147], v[56:59], v[112:115], v[144:147]
  v_mfma_f32_16x16x32_bf16 v[148:151], v[60:63], v[116:119], v[148:151]
  v_mfma_f32_16x16x32_bf16 v[144:147], v[64:67], v[120:123], v[144:147]
  v_mfma_f32_16x16x32_bf16 v[148:151], v[68:71], v[124:127], v[148:151]
  v_mfma_f32_16x16x32_bf16 v[144:147], v[72:75], v[128:131], v[144:147]
  v_mfma_f32_16x16x32_bf16 v[148:151], v[76:79], v[132:135], v[148:151]
  v_mfma_f32_16x16x32_bf16 v[144:147], v[80:83], v[136:139], v[144:147]
  v_mfma_f32_16x16x32_bf16 v[148:151], v[84:87], v[140:143], v[148:151]
  s_lshl_b32 s36, s23, 2
  s_mul_i32 s37, s22, 34816
  s_add_u32 s36, s36, s37
  s_add_u32 s36, s36, 0xa80000
  s_cmp_ge_u32 s22, 1
  s_nop 2
  v_add_f32 v144, v144, v148
  v_add_f32 v145, v145, v149
  v_add_f32 v146, v146, v150
  v_add_f32 v147, v147, v151
  s_mov_b64 exec, s[54:55]
  ds_write_b128 v8, v[144:147] offset:57472
  s_waitcnt lgkmcnt(0)
  s_barrier
  s_cbranch_scc1 F_cn2
  ds_read_b128 v[156:159], v7 offset:57600
  ds_read_b128 v[160:163], v7 offset:57728
  ds_read_b128 v[164:167], v7 offset:57856
  s_waitcnt lgkmcnt(2)
  v_add_f32 v144, v144, v156
  v_add_f32 v145, v145, v157
  v_add_f32 v146, v146, v158
  v_add_f32 v147, v147, v159
  s_waitcnt lgkmcnt(1)
  v_add_f32 v144, v144, v160
  v_add_f32 v145, v145, v161
  v_add_f32 v146, v146, v162
  v_add_f32 v147, v147, v163
  s_waitcnt lgkmcnt(0)
  v_add_f32 v144, v144, v164
  v_add_f32 v145, v145, v165
  v_add_f32 v146, v146, v166
  v_add_f32 v147, v147, v167
  v_fma_f32 v144, v144, v20, v22
  v_fma_f32 v145, v145, v20, v23
  v_fma_f32 v146, v146, v20, v24
  v_fma_f32 v147, v147, v20, v25
  v_cvt_pk_bf16_f32 v18, v144, v145
  v_cvt_pk_bf16_f32 v19, v146, v147
  buffer_store_dwordx2 v[18:19], v10, s[8:11], s23 offen
F_cn2:
  s_mov_b64 exec, -1
  s_setprio 0
  s_endpgm
WENDD:
F_end:
  s_endpgm
  .set CODE_END, F_end - interleave_layers__spectral_fnet__moe_arch_mod__prompt_kernel - 64
.section .rodata,"a"
.p2align 6
.amdhsa_kernel interleave_layers__spectral_fnet__moe_arch_mod__prompt_kernel
  .amdhsa_next_free_vgpr 256
  .amdhsa_next_free_sgpr 102
  .amdhsa_accum_offset 256
  .amdhsa_group_segment_fixed_size 0
  .amdhsa_kernarg_size 104
  .amdhsa_user_sgpr_count 2
  .amdhsa_user_sgpr_kernarg_segment_ptr 1
  .amdhsa_system_sgpr_workgroup_id_x 1
.end_amdhsa_kernel
```
